```python
import torch

def _softmax(x, axis=-1):
    return torch.softmax(x, dim=axis)
def _gelu(x):
    return torch.nn.functional.gelu(x, approximate="tanh")
def _silu(x):
    return torch.nn.functional.silu(x)
def _sigmoid(x):
    return torch.sigmoid(x)
def _layernorm(x, axis=-1, eps=1e-5):
    m = x.mean(dim=axis, keepdim=True)
    v = x.var(dim=axis, keepdim=True, unbiased=False)
    return (x - m) / torch.sqrt(v + eps)
def _scatter_add(tgt, idx, src, axis=0):
    return tgt.clone().index_add_(axis, idx, src)
def _segment_sum(src, seg, n):
    out = torch.zeros((n,) + src.shape[1:], dtype=src.dtype)
    return out.index_add_(0, seg, src)
def _pad(x, pw):
    flat = tuple(v for pair in reversed(pw) for v in pair)
    return torch.nn.functional.pad(x, flat)

kernel_name = 'sequential_preLN__mha_block_cached__geglu_ffn__decode'

def setup_inputs():

    _w = (lambda a: (lambda t: t.to(torch.bfloat16) if t.is_floating_point() else t)(torch.as_tensor(a)))
    def _A_setup():
        B, Sq, D = 1, 1, 512
        H, Sk, Dh = 32, 16384, 128
        return {
            "x": _w((lambda *s: torch.randn(*s, dtype=torch.bfloat16) * 0.05)(B, Sq, D)),
            "k_cache": _w((lambda *s: torch.randn(*s, dtype=torch.bfloat16) * 3.2)(B, H, Sk, Dh)),
            "v_cache": _w((lambda *s: torch.randn(*s, dtype=torch.bfloat16) * 0.4)(B, H, Sk, Dh)),
            "wq": _w((lambda *s: torch.randn(*s, dtype=torch.bfloat16) * 3.2)(D, H * Dh) * (D ** -0.5)),
            "wo": _w((lambda *s: torch.randn(*s, dtype=torch.bfloat16) * 0.4)(H * Dh, D) * ((H * Dh) ** -0.5)),
        }
    _A_in = _A_setup()

    def _B_setup():
        B, S, D, F = 1, 1, 512, 1792
        return {
            "x": _w((lambda *s: torch.randn(*s, dtype=torch.bfloat16) * 0.05)(B, S, D)),
            "w_gate": _w((lambda *s: torch.randn(*s, dtype=torch.bfloat16) * 0.05)(D, F)),
            "w_up": _w((lambda *s: torch.randn(*s, dtype=torch.bfloat16) * 0.05)(D, F)),
            "w_down": _w((lambda *s: torch.randn(*s, dtype=torch.bfloat16) * 0.05)(F, D)),
        }
    _B_in = _B_setup()

    return {
        "A_x": _A_in["x"],
        "A_k_cache": _A_in["k_cache"],
        "A_v_cache": _A_in["v_cache"],
        "A_wq": _A_in["wq"],
        "A_wo": _A_in["wo"],
        "B_x": _B_in["x"],
        "B_w_gate": _B_in["w_gate"],
        "B_w_up": _B_in["w_up"],
        "B_w_down": _B_in["w_down"],
    }

def reference(A_x, A_k_cache, A_v_cache, A_wq, A_wo, B_x, B_w_gate, B_w_up, B_w_down):
    def _A_ref(x, k_cache, v_cache, wq, wo):
        B, Sq, D = x.shape
        H, Dh = 32, 128
        q = (lambda x, *d: x.permute(*d))((x @ wq).reshape(B, Sq, H, Dh), 0, 2, 1, 3)
        scores = torch.einsum("bhqd,bhkd->bhqk", q, k_cache) * (Dh ** -0.5)
        p = _softmax(scores, axis=-1)
        o = torch.einsum("bhqk,bhkd->bhqd", p, v_cache)
        return (lambda x, *d: x.permute(*d))(o, 0, 2, 1, 3).reshape(B, Sq, H * Dh) @ wo

    def _B_ref(x, w_gate, w_up, w_down):
        return (_gelu(x @ w_gate) * (x @ w_up)) @ w_down

    x = A_x
    h = x + _A_ref(_layernorm(x, axis=-1), A_k_cache, A_v_cache, A_wq, A_wo)
    h2 = h + _B_ref(_layernorm(h, axis=-1), B_w_gate, B_w_up, B_w_down)
    return h2
```

```asm
; @launch kernel=attn_kernel grid=(256,1,1) block=(512,1,1) lds=36864
; @launch kernel=wo_kernel grid=(256,1,1) block=(256,1,1) lds=8192
; @launch kernel=ffn1_kernel grid=(112,1,1) block=(256,1,1) lds=8192
; @launch kernel=ffn2_kernel grid=(64,1,1) block=(256,1,1) lds=4096
.amdgcn_target "amdgcn-amd-amdhsa--gfx950"
.text
.globl attn_kernel
.p2align 8
.type attn_kernel,@function
attn_kernel:
    s_cmp_ge_u32 s2, 256
    s_cbranch_scc1 L_attn_end
    s_load_dwordx8 s[24:31], s[0:1], 0
    s_load_dwordx2 s[32:33], s[0:1], 88
    s_load_dwordx2 s[68:69], s[0:1], 32
    s_load_dwordx4 s[72:75], s[0:1], 48
    s_load_dwordx2 s[70:71], s[0:1], 64
    s_and_b32 s37, s2, 7
    s_lshr_b32 s38, s2, 3
    s_and_b32 s38, s38, 3
    s_lshl_b32 s34, s37, 2
    s_add_u32 s34, s34, s38
    s_lshr_b32 s35, s2, 5
    v_and_b32 v1, 63, v0
    v_lshrrev_b32 v5, 6, v0
    s_nop 0
    v_readfirstlane_b32 s36, v5
    s_lshl_b32 s39, s35, 19
    v_lshlrev_b32 v6, 14, v5
    v_lshlrev_b32 v2, 4, v1
    v_add_u32 v2, v2, v6
    v_add_u32 v2, s39, v2
    v_lshrrev_b32 v7, 4, v1
    v_lshlrev_b32 v8, 6, v5
    v_add_u32 v7, v7, v8
    v_lshlrev_b32 v3, 13, v7
    v_and_b32 v6, 15, v1
    v_lshlrev_b32 v6, 4, v6
    v_add_u32 v3, v3, v6
    s_lshl_b32 s39, s34, 8
    v_add_u32 v3, s39, v3
    v_lshlrev_b32 v4, 4, v1
    s_mov_b32 s44, 0x22222222
    s_mov_b32 s45, 0x22222222
    s_mov_b32 s46, 0x44444444
    s_mov_b32 s47, 0x44444444
    s_mov_b32 s48, 0x88888888
    s_mov_b32 s49, 0x88888888
    s_waitcnt lgkmcnt(0)
    s_mov_b32 s4, s24
    s_mov_b32 s5, s25
    s_mov_b32 s6, 0x400
    s_mov_b32 s7, 0x00020000
    s_lshl_b32 s39, s34, 22
    s_add_u32 s26, s26, s39
    s_addc_u32 s27, s27, 0
    s_add_u32 s28, s28, s39
    s_addc_u32 s29, s29, 0
    s_mov_b32 s8, s26
    s_mov_b32 s9, s27
    s_mov_b32 s10, 0x400000
    s_mov_b32 s11, 0x00020000
    s_mov_b32 s12, s28
    s_mov_b32 s13, s29
    s_mov_b32 s14, 0x400000
    s_mov_b32 s15, 0x00020000
    s_mov_b32 s16, s30
    s_mov_b32 s17, s31
    s_mov_b32 s18, 0x400000
    s_mov_b32 s19, 0x00020000
    s_mov_b32 s20, s32
    s_mov_b32 s21, s33
    s_mov_b32 s22, 0x60000
    s_mov_b32 s23, 0x00020000
    s_mov_b32 s52, s68
    s_mov_b32 s53, s69
    s_mov_b32 s54, 0x400000
    s_mov_b32 s55, 0x00020000
    s_mov_b32 s56, s72
    s_mov_b32 s57, s73
    s_mov_b32 s58, 0x1c0000
    s_mov_b32 s59, 0x00020000
    s_mov_b32 s60, s74
    s_mov_b32 s61, s75
    s_mov_b32 s62, 0x1c0000
    s_mov_b32 s63, 0x00020000
    s_mov_b32 s64, s70
    s_mov_b32 s65, s71
    s_mov_b32 s66, 0x1c0000
    s_mov_b32 s67, 0x00020000
    buffer_load_dwordx4 v[8:11], v4, s[4:7], 0 offen
    s_mov_b32 s40, 0x0
    buffer_load_dwordx4 v[192:195], v3, s[16:19], s40 offen
    s_mov_b32 s40, 0x8000
    buffer_load_dwordx4 v[196:199], v3, s[16:19], s40 offen
    s_mov_b32 s40, 0x10000
    buffer_load_dwordx4 v[200:203], v3, s[16:19], s40 offen
    s_mov_b32 s40, 0x18000
    buffer_load_dwordx4 v[204:207], v3, s[16:19], s40 offen
    s_mov_b32 s40, 0x20000
    buffer_load_dwordx4 v[208:211], v3, s[16:19], s40 offen
    s_mov_b32 s40, 0x28000
    buffer_load_dwordx4 v[212:215], v3, s[16:19], s40 offen
    s_mov_b32 s40, 0x30000
    buffer_load_dwordx4 v[216:219], v3, s[16:19], s40 offen
    s_mov_b32 s40, 0x38000
    buffer_load_dwordx4 v[220:223], v3, s[16:19], s40 offen
    s_mov_b32 s40, 0x40000
    buffer_load_dwordx4 v[224:227], v3, s[16:19], s40 offen
    s_mov_b32 s40, 0x48000
    buffer_load_dwordx4 v[228:231], v3, s[16:19], s40 offen
    s_mov_b32 s40, 0x50000
    buffer_load_dwordx4 v[232:235], v3, s[16:19], s40 offen
    s_mov_b32 s40, 0x58000
    buffer_load_dwordx4 v[236:239], v3, s[16:19], s40 offen
    s_mov_b32 s40, 0x60000
    buffer_load_dwordx4 v[240:243], v3, s[16:19], s40 offen
    s_mov_b32 s40, 0x68000
    buffer_load_dwordx4 v[244:247], v3, s[16:19], s40 offen
    s_mov_b32 s40, 0x70000
    buffer_load_dwordx4 v[248:251], v3, s[16:19], s40 offen
    s_mov_b32 s40, 0x78000
    buffer_load_dwordx4 v[252:255], v3, s[16:19], s40 offen
    s_mov_b32 s40, 0x0
    buffer_load_dwordx4 v[64:67], v2, s[8:11], s40 offen offset:0 nt
    buffer_load_dwordx4 v[68:71], v2, s[8:11], s40 offen offset:1024 nt
    buffer_load_dwordx4 v[72:75], v2, s[8:11], s40 offen offset:2048 nt
    buffer_load_dwordx4 v[76:79], v2, s[8:11], s40 offen offset:3072 nt
    s_mov_b32 s40, 0x1000
    buffer_load_dwordx4 v[80:83], v2, s[8:11], s40 offen offset:0 nt
    buffer_load_dwordx4 v[84:87], v2, s[8:11], s40 offen offset:1024 nt
    buffer_load_dwordx4 v[88:91], v2, s[8:11], s40 offen offset:2048 nt
    buffer_load_dwordx4 v[92:95], v2, s[8:11], s40 offen offset:3072 nt
    s_mov_b32 s40, 0x2000
    buffer_load_dwordx4 v[96:99], v2, s[8:11], s40 offen offset:0 nt
    buffer_load_dwordx4 v[100:103], v2, s[8:11], s40 offen offset:1024 nt
    buffer_load_dwordx4 v[104:107], v2, s[8:11], s40 offen offset:2048 nt
    buffer_load_dwordx4 v[108:111], v2, s[8:11], s40 offen offset:3072 nt
    s_mov_b32 s40, 0x3000
    buffer_load_dwordx4 v[112:115], v2, s[8:11], s40 offen offset:0 nt
    buffer_load_dwordx4 v[116:119], v2, s[8:11], s40 offen offset:1024 nt
    buffer_load_dwordx4 v[120:123], v2, s[8:11], s40 offen offset:2048 nt
    buffer_load_dwordx4 v[124:127], v2, s[8:11], s40 offen offset:3072 nt
    s_mov_b32 s40, 0x20000
    buffer_load_dwordx4 v[128:131], v2, s[8:11], s40 offen offset:0 nt
    buffer_load_dwordx4 v[132:135], v2, s[8:11], s40 offen offset:1024 nt
    buffer_load_dwordx4 v[136:139], v2, s[8:11], s40 offen offset:2048 nt
    buffer_load_dwordx4 v[140:143], v2, s[8:11], s40 offen offset:3072 nt
    s_mov_b32 s40, 0x21000
    buffer_load_dwordx4 v[144:147], v2, s[8:11], s40 offen offset:0 nt
    buffer_load_dwordx4 v[148:151], v2, s[8:11], s40 offen offset:1024 nt
    buffer_load_dwordx4 v[152:155], v2, s[8:11], s40 offen offset:2048 nt
    buffer_load_dwordx4 v[156:159], v2, s[8:11], s40 offen offset:3072 nt
    s_mov_b32 s40, 0x22000
    buffer_load_dwordx4 v[160:163], v2, s[8:11], s40 offen offset:0 nt
    buffer_load_dwordx4 v[164:167], v2, s[8:11], s40 offen offset:1024 nt
    buffer_load_dwordx4 v[168:171], v2, s[8:11], s40 offen offset:2048 nt
    buffer_load_dwordx4 v[172:175], v2, s[8:11], s40 offen offset:3072 nt
    s_mov_b32 s40, 0x23000
    buffer_load_dwordx4 v[176:179], v2, s[8:11], s40 offen offset:0 nt
    buffer_load_dwordx4 v[180:183], v2, s[8:11], s40 offen offset:1024 nt
    buffer_load_dwordx4 v[184:187], v2, s[8:11], s40 offen offset:2048 nt
    buffer_load_dwordx4 v[188:191], v2, s[8:11], s40 offen offset:3072 nt
    s_waitcnt vmcnt(48)
    v_lshlrev_b32 v12, 16, v8
    v_and_b32 v13, 0xffff0000, v8
    v_lshlrev_b32 v14, 16, v9
    v_and_b32 v15, 0xffff0000, v9
    v_lshlrev_b32 v16, 16, v10
    v_and_b32 v17, 0xffff0000, v10
    v_lshlrev_b32 v18, 16, v11
    v_and_b32 v19, 0xffff0000, v11
    v_add_f32 v20, v12, v13
    v_add_f32 v20, v20, v14
    v_add_f32 v20, v20, v15
    v_add_f32 v20, v20, v16
    v_add_f32 v20, v20, v17
    v_add_f32 v20, v20, v18
    v_add_f32 v20, v20, v19
    s_nop 1
    v_add_f32_dpp v20, v20, v20 row_ror:8 row_mask:0xf bank_mask:0xf
    s_nop 1
    v_add_f32_dpp v20, v20, v20 row_ror:4 row_mask:0xf bank_mask:0xf
    s_nop 1
    v_add_f32_dpp v20, v20, v20 row_ror:2 row_mask:0xf bank_mask:0xf
    s_nop 1
    v_add_f32_dpp v20, v20, v20 row_ror:1 row_mask:0xf bank_mask:0xf
    v_mov_b32 v21, v20
    s_nop 1
    v_permlane16_swap_b32 v20, v21
    v_add_f32 v20, v20, v21
    v_mov_b32 v21, v20
    s_nop 1
    v_permlane32_swap_b32 v20, v21
    v_add_f32 v20, v20, v21
    v_mul_f32 v20, 0x3b000000, v20
    v_mov_b32 v23, 0
    v_sub_f32 v24, v12, v20
    v_fma_f32 v23, v24, v24, v23
    v_sub_f32 v24, v13, v20
    v_fma_f32 v23, v24, v24, v23
    v_sub_f32 v24, v14, v20
    v_fma_f32 v23, v24, v24, v23
    v_sub_f32 v24, v15, v20
    v_fma_f32 v23, v24, v24, v23
    v_sub_f32 v24, v16, v20
    v_fma_f32 v23, v24, v24, v23
    v_sub_f32 v24, v17, v20
    v_fma_f32 v23, v24, v24, v23
    v_sub_f32 v24, v18, v20
    v_fma_f32 v23, v24, v24, v23
    v_sub_f32 v24, v19, v20
    v_fma_f32 v23, v24, v24, v23
    s_nop 1
    v_add_f32_dpp v23, v23, v23 row_ror:8 row_mask:0xf bank_mask:0xf
    s_nop 1
    v_add_f32_dpp v23, v23, v23 row_ror:4 row_mask:0xf bank_mask:0xf
    s_nop 1
    v_add_f32_dpp v23, v23, v23 row_ror:2 row_mask:0xf bank_mask:0xf
    s_nop 1
    v_add_f32_dpp v23, v23, v23 row_ror:1 row_mask:0xf bank_mask:0xf
    v_mov_b32 v21, v23
    s_nop 1
    v_permlane16_swap_b32 v23, v21
    v_add_f32 v23, v23, v21
    v_mov_b32 v21, v23
    s_nop 1
    v_permlane32_swap_b32 v23, v21
    v_add_f32 v23, v23, v21
    v_mul_f32 v23, 0x3b000000, v23
    v_cvt_pk_bf16_f32 v24, v20, v20
    v_lshlrev_b32 v24, 16, v24
    v_cvt_pk_bf16_f32 v25, v23, v23
    v_lshlrev_b32 v25, 16, v25
    v_add_f32 v25, 0x3727c5ac, v25
    v_cvt_pk_bf16_f32 v25, v25, v25
    v_lshlrev_b32 v25, 16, v25
    v_sqrt_f32 v25, v25
    s_nop 0
    v_cvt_pk_bf16_f32 v25, v25, v25
    v_lshlrev_b32 v25, 16, v25
    v_sub_f32 v26, v12, v24
    v_cvt_pk_bf16_f32 v26, v26, v26
    v_lshlrev_b32 v26, 16, v26
    v_rcp_f32 v28, v25
    s_nop 0
    v_mul_f32 v27, v26, v28
    v_fma_f32 v29, -v27, v25, v26
    v_fma_f32 v27, v29, v28, v27
    v_cvt_pk_bf16_f32 v40, v27, 0
    v_sub_f32 v26, v13, v24
    v_cvt_pk_bf16_f32 v26, v26, v26
    v_lshlrev_b32 v26, 16, v26
    v_rcp_f32 v28, v25
    s_nop 0
    v_mul_f32 v27, v26, v28
    v_fma_f32 v29, -v27, v25, v26
    v_fma_f32 v27, v29, v28, v27
    v_cvt_pk_bf16_f32 v41, v27, 0
    v_sub_f32 v26, v14, v24
    v_cvt_pk_bf16_f32 v26, v26, v26
    v_lshlrev_b32 v26, 16, v26
    v_rcp_f32 v28, v25
    s_nop 0
    v_mul_f32 v27, v26, v28
    v_fma_f32 v29, -v27, v25, v26
    v_fma_f32 v27, v29, v28, v27
    v_cvt_pk_bf16_f32 v42, v27, 0
    v_sub_f32 v26, v15, v24
    v_cvt_pk_bf16_f32 v26, v26, v26
    v_lshlrev_b32 v26, 16, v26
    v_rcp_f32 v28, v25
    s_nop 0
    v_mul_f32 v27, v26, v28
    v_fma_f32 v29, -v27, v25, v26
    v_fma_f32 v27, v29, v28, v27
    v_cvt_pk_bf16_f32 v43, v27, 0
    v_sub_f32 v26, v16, v24
    v_cvt_pk_bf16_f32 v26, v26, v26
    v_lshlrev_b32 v26, 16, v26
    v_rcp_f32 v28, v25
    s_nop 0
    v_mul_f32 v27, v26, v28
    v_fma_f32 v29, -v27, v25, v26
    v_fma_f32 v27, v29, v28, v27
    v_cvt_pk_bf16_f32 v44, v27, 0
    v_sub_f32 v26, v17, v24
    v_cvt_pk_bf16_f32 v26, v26, v26
    v_lshlrev_b32 v26, 16, v26
    v_rcp_f32 v28, v25
    s_nop 0
    v_mul_f32 v27, v26, v28
    v_fma_f32 v29, -v27, v25, v26
    v_fma_f32 v27, v29, v28, v27
    v_cvt_pk_bf16_f32 v45, v27, 0
    v_sub_f32 v26, v18, v24
    v_cvt_pk_bf16_f32 v26, v26, v26
    v_lshlrev_b32 v26, 16, v26
    v_rcp_f32 v28, v25
    s_nop 0
    v_mul_f32 v27, v26, v28
    v_fma_f32 v29, -v27, v25, v26
    v_fma_f32 v27, v29, v28, v27
    v_cvt_pk_bf16_f32 v46, v27, 0
    v_sub_f32 v26, v19, v24
    v_cvt_pk_bf16_f32 v26, v26, v26
    v_lshlrev_b32 v26, 16, v26
    v_rcp_f32 v28, v25
    s_nop 0
    v_mul_f32 v27, v26, v28
    v_fma_f32 v29, -v27, v25, v26
    v_fma_f32 v27, v29, v28, v27
    v_cvt_pk_bf16_f32 v47, v27, 0
    v_lshlrev_b32 v26, 11, v5
    v_lshlrev_b32 v27, 5, v1
    v_add_u32 v26, v26, v27
    ds_write_b128 v26, v[40:43] offset:0
    ds_write_b128 v26, v[44:47] offset:16
    v_lshlrev_b32 v59, 2, v7
    v_lshlrev_b32 v58, 11, v5
    v_add_u32 v59, v59, v58
    s_waitcnt lgkmcnt(0)
    ds_read_b32 v16, v59 offset:0
    ds_read_b32 v17, v59 offset:16
    ds_read_b32 v18, v59 offset:32
    ds_read_b32 v19, v59 offset:48
    ds_read_b32 v20, v59 offset:64
    ds_read_b32 v21, v59 offset:80
    ds_read_b32 v22, v59 offset:96
    ds_read_b32 v23, v59 offset:112
    ds_read_b32 v24, v59 offset:128
    ds_read_b32 v25, v59 offset:144
    ds_read_b32 v26, v59 offset:160
    ds_read_b32 v27, v59 offset:176
    ds_read_b32 v28, v59 offset:192
    ds_read_b32 v29, v59 offset:208
    ds_read_b32 v30, v59 offset:224
    ds_read_b32 v31, v59 offset:240
    s_waitcnt vmcnt(32) lgkmcnt(0)
    v_lshlrev_b32 v57, 16, v16
    v_dot2_f32_bf16 v48, v16, v192, 0
    v_dot2_f32_bf16 v49, v57, v192, 0
    v_dot2_f32_bf16 v50, v16, v193, 0
    v_dot2_f32_bf16 v51, v57, v193, 0
    v_dot2_f32_bf16 v52, v16, v194, 0
    v_dot2_f32_bf16 v53, v57, v194, 0
    v_dot2_f32_bf16 v54, v16, v195, 0
    v_dot2_f32_bf16 v55, v57, v195, 0
    v_lshlrev_b32 v57, 16, v17
    v_dot2c_f32_bf16 v48, v17, v196
    v_dot2c_f32_bf16 v49, v57, v196
    v_dot2c_f32_bf16 v50, v17, v197
    v_dot2c_f32_bf16 v51, v57, v197
    v_dot2c_f32_bf16 v52, v17, v198
    v_dot2c_f32_bf16 v53, v57, v198
    v_dot2c_f32_bf16 v54, v17, v199
    v_dot2c_f32_bf16 v55, v57, v199
    v_lshlrev_b32 v57, 16, v18
    v_dot2c_f32_bf16 v48, v18, v200
    v_dot2c_f32_bf16 v49, v57, v200
    v_dot2c_f32_bf16 v50, v18, v201
    v_dot2c_f32_bf16 v51, v57, v201
    v_dot2c_f32_bf16 v52, v18, v202
    v_dot2c_f32_bf16 v53, v57, v202
    v_dot2c_f32_bf16 v54, v18, v203
    v_dot2c_f32_bf16 v55, v57, v203
    v_lshlrev_b32 v57, 16, v19
    v_dot2c_f32_bf16 v48, v19, v204
    v_dot2c_f32_bf16 v49, v57, v204
    v_dot2c_f32_bf16 v50, v19, v205
    v_dot2c_f32_bf16 v51, v57, v205
    v_dot2c_f32_bf16 v52, v19, v206
    v_dot2c_f32_bf16 v53, v57, v206
    v_dot2c_f32_bf16 v54, v19, v207
    v_dot2c_f32_bf16 v55, v57, v207
    v_lshlrev_b32 v57, 16, v20
    v_dot2c_f32_bf16 v48, v20, v208
    v_dot2c_f32_bf16 v49, v57, v208
    v_dot2c_f32_bf16 v50, v20, v209
    v_dot2c_f32_bf16 v51, v57, v209
    v_dot2c_f32_bf16 v52, v20, v210
    v_dot2c_f32_bf16 v53, v57, v210
    v_dot2c_f32_bf16 v54, v20, v211
    v_dot2c_f32_bf16 v55, v57, v211
    v_lshlrev_b32 v57, 16, v21
    v_dot2c_f32_bf16 v48, v21, v212
    v_dot2c_f32_bf16 v49, v57, v212
    v_dot2c_f32_bf16 v50, v21, v213
    v_dot2c_f32_bf16 v51, v57, v213
    v_dot2c_f32_bf16 v52, v21, v214
    v_dot2c_f32_bf16 v53, v57, v214
    v_dot2c_f32_bf16 v54, v21, v215
    v_dot2c_f32_bf16 v55, v57, v215
    v_lshlrev_b32 v57, 16, v22
    v_dot2c_f32_bf16 v48, v22, v216
    v_dot2c_f32_bf16 v49, v57, v216
    v_dot2c_f32_bf16 v50, v22, v217
    v_dot2c_f32_bf16 v51, v57, v217
    v_dot2c_f32_bf16 v52, v22, v218
    v_dot2c_f32_bf16 v53, v57, v218
    v_dot2c_f32_bf16 v54, v22, v219
    v_dot2c_f32_bf16 v55, v57, v219
    v_lshlrev_b32 v57, 16, v23
    v_dot2c_f32_bf16 v48, v23, v220
    v_dot2c_f32_bf16 v49, v57, v220
    v_dot2c_f32_bf16 v50, v23, v221
    v_dot2c_f32_bf16 v51, v57, v221
    v_dot2c_f32_bf16 v52, v23, v222
    v_dot2c_f32_bf16 v53, v57, v222
    v_dot2c_f32_bf16 v54, v23, v223
    v_dot2c_f32_bf16 v55, v57, v223
    v_lshlrev_b32 v57, 16, v24
    v_dot2c_f32_bf16 v48, v24, v224
    v_dot2c_f32_bf16 v49, v57, v224
    v_dot2c_f32_bf16 v50, v24, v225
    v_dot2c_f32_bf16 v51, v57, v225
    v_dot2c_f32_bf16 v52, v24, v226
    v_dot2c_f32_bf16 v53, v57, v226
    v_dot2c_f32_bf16 v54, v24, v227
    v_dot2c_f32_bf16 v55, v57, v227
    v_lshlrev_b32 v57, 16, v25
    v_dot2c_f32_bf16 v48, v25, v228
    v_dot2c_f32_bf16 v49, v57, v228
    v_dot2c_f32_bf16 v50, v25, v229
    v_dot2c_f32_bf16 v51, v57, v229
    v_dot2c_f32_bf16 v52, v25, v230
    v_dot2c_f32_bf16 v53, v57, v230
    v_dot2c_f32_bf16 v54, v25, v231
    v_dot2c_f32_bf16 v55, v57, v231
    v_lshlrev_b32 v57, 16, v26
    v_dot2c_f32_bf16 v48, v26, v232
    v_dot2c_f32_bf16 v49, v57, v232
    v_dot2c_f32_bf16 v50, v26, v233
    v_dot2c_f32_bf16 v51, v57, v233
    v_dot2c_f32_bf16 v52, v26, v234
    v_dot2c_f32_bf16 v53, v57, v234
    v_dot2c_f32_bf16 v54, v26, v235
    v_dot2c_f32_bf16 v55, v57, v235
    v_lshlrev_b32 v57, 16, v27
    v_dot2c_f32_bf16 v48, v27, v236
    v_dot2c_f32_bf16 v49, v57, v236
    v_dot2c_f32_bf16 v50, v27, v237
    v_dot2c_f32_bf16 v51, v57, v237
    v_dot2c_f32_bf16 v52, v27, v238
    v_dot2c_f32_bf16 v53, v57, v238
    v_dot2c_f32_bf16 v54, v27, v239
    v_dot2c_f32_bf16 v55, v57, v239
    v_lshlrev_b32 v57, 16, v28
    v_dot2c_f32_bf16 v48, v28, v240
    v_dot2c_f32_bf16 v49, v57, v240
    v_dot2c_f32_bf16 v50, v28, v241
    v_dot2c_f32_bf16 v51, v57, v241
    v_dot2c_f32_bf16 v52, v28, v242
    v_dot2c_f32_bf16 v53, v57, v242
    v_dot2c_f32_bf16 v54, v28, v243
    v_dot2c_f32_bf16 v55, v57, v243
    v_lshlrev_b32 v57, 16, v29
    v_dot2c_f32_bf16 v48, v29, v244
    v_dot2c_f32_bf16 v49, v57, v244
    v_dot2c_f32_bf16 v50, v29, v245
    v_dot2c_f32_bf16 v51, v57, v245
    v_dot2c_f32_bf16 v52, v29, v246
    v_dot2c_f32_bf16 v53, v57, v246
    v_dot2c_f32_bf16 v54, v29, v247
    v_dot2c_f32_bf16 v55, v57, v247
    v_lshlrev_b32 v57, 16, v30
    v_dot2c_f32_bf16 v48, v30, v248
    v_dot2c_f32_bf16 v49, v57, v248
    v_dot2c_f32_bf16 v50, v30, v249
    v_dot2c_f32_bf16 v51, v57, v249
    v_dot2c_f32_bf16 v52, v30, v250
    v_dot2c_f32_bf16 v53, v57, v250
    v_dot2c_f32_bf16 v54, v30, v251
    v_dot2c_f32_bf16 v55, v57, v251
    v_lshlrev_b32 v57, 16, v31
    v_dot2c_f32_bf16 v48, v31, v252
    v_dot2c_f32_bf16 v49, v57, v252
    v_dot2c_f32_bf16 v50, v31, v253
    v_dot2c_f32_bf16 v51, v57, v253
    v_dot2c_f32_bf16 v52, v31, v254
    v_dot2c_f32_bf16 v53, v57, v254
    v_dot2c_f32_bf16 v54, v31, v255
    v_dot2c_f32_bf16 v55, v57, v255
    s_mov_b32 s40, 0x40000
    buffer_load_dwordx4 v[192:195], v2, s[8:11], s40 offen offset:0 nt
    buffer_load_dwordx4 v[196:199], v2, s[8:11], s40 offen offset:1024 nt
    buffer_load_dwordx4 v[200:203], v2, s[8:11], s40 offen offset:2048 nt
    buffer_load_dwordx4 v[204:207], v2, s[8:11], s40 offen offset:3072 nt
    s_mov_b32 s40, 0x41000
    buffer_load_dwordx4 v[208:211], v2, s[8:11], s40 offen offset:0 nt
    buffer_load_dwordx4 v[212:215], v2, s[8:11], s40 offen offset:1024 nt
    buffer_load_dwordx4 v[216:219], v2, s[8:11], s40 offen offset:2048 nt
    buffer_load_dwordx4 v[220:223], v2, s[8:11], s40 offen offset:3072 nt
    s_mov_b32 s40, 0x42000
    buffer_load_dwordx4 v[224:227], v2, s[8:11], s40 offen offset:0 nt
    buffer_load_dwordx4 v[228:231], v2, s[8:11], s40 offen offset:1024 nt
    buffer_load_dwordx4 v[232:235], v2, s[8:11], s40 offen offset:2048 nt
    buffer_load_dwordx4 v[236:239], v2, s[8:11], s40 offen offset:3072 nt
    s_mov_b32 s40, 0x43000
    buffer_load_dwordx4 v[240:243], v2, s[8:11], s40 offen offset:0 nt
    buffer_load_dwordx4 v[244:247], v2, s[8:11], s40 offen offset:1024 nt
    buffer_load_dwordx4 v[248:251], v2, s[8:11], s40 offen offset:2048 nt
    buffer_load_dwordx4 v[252:255], v2, s[8:11], s40 offen offset:3072 nt
    v_lshlrev_b32 v26, 5, v0
    ds_write_b128 v26, v[48:51] offset:16384
    ds_write_b128 v26, v[52:55] offset:16400
    s_waitcnt lgkmcnt(0)
    s_barrier
    s_cmp_ge_u32 s36, 2
    s_cbranch_scc1 L_attn_q_done
    v_lshlrev_b32 v59, 2, v0
    ds_read_b32 v16, v59 offset:16384
    ds_read_b32 v17, v59 offset:16896
    ds_read_b32 v18, v59 offset:17408
    ds_read_b32 v19, v59 offset:17920
    ds_read_b32 v20, v59 offset:18432
    ds_read_b32 v21, v59 offset:18944
    ds_read_b32 v22, v59 offset:19456
    ds_read_b32 v23, v59 offset:19968
    ds_read_b32 v24, v59 offset:20480
    ds_read_b32 v25, v59 offset:20992
    ds_read_b32 v26, v59 offset:21504
    ds_read_b32 v27, v59 offset:22016
    ds_read_b32 v28, v59 offset:22528
    ds_read_b32 v29, v59 offset:23040
    ds_read_b32 v30, v59 offset:23552
    ds_read_b32 v31, v59 offset:24064
    s_waitcnt lgkmcnt(0)
    v_mov_b32 v57, v16
    v_add_f32 v57, v57, v17
    v_add_f32 v57, v57, v18
    v_add_f32 v57, v57, v19
    v_add_f32 v57, v57, v20
    v_add_f32 v57, v57, v21
    v_add_f32 v57, v57, v22
    v_add_f32 v57, v57, v23
    v_add_f32 v57, v57, v24
    v_add_f32 v57, v57, v25
    v_add_f32 v57, v57, v26
    v_add_f32 v57, v57, v27
    v_add_f32 v57, v57, v28
    v_add_f32 v57, v57, v29
    v_add_f32 v57, v57, v30
    v_add_f32 v57, v57, v31
    ds_read_b32 v16, v59 offset:24576
    ds_read_b32 v17, v59 offset:25088
    ds_read_b32 v18, v59 offset:25600
    ds_read_b32 v19, v59 offset:26112
    ds_read_b32 v20, v59 offset:26624
    ds_read_b32 v21, v59 offset:27136
    ds_read_b32 v22, v59 offset:27648
    ds_read_b32 v23, v59 offset:28160
    ds_read_b32 v24, v59 offset:28672
    ds_read_b32 v25, v59 offset:29184
    ds_read_b32 v26, v59 offset:29696
    ds_read_b32 v27, v59 offset:30208
    ds_read_b32 v28, v59 offset:30720
    ds_read_b32 v29, v59 offset:31232
    ds_read_b32 v30, v59 offset:31744
    ds_read_b32 v31, v59 offset:32256
    s_waitcnt lgkmcnt(0)
    v_add_f32 v57, v57, v16
    v_add_f32 v57, v57, v17
    v_add_f32 v57, v57, v18
    v_add_f32 v57, v57, v19
    v_add_f32 v57, v57, v20
    v_add_f32 v57, v57, v21
    v_add_f32 v57, v57, v22
    v_add_f32 v57, v57, v23
    v_add_f32 v57, v57, v24
    v_add_f32 v57, v57, v25
    v_add_f32 v57, v57, v26
    v_add_f32 v57, v57, v27
    v_add_f32 v57, v57, v28
    v_add_f32 v57, v57, v29
    v_add_f32 v57, v57, v30
    v_add_f32 v57, v57, v31
    v_cvt_pk_bf16_f32 v57, v57, 0
    v_lshlrev_b32 v28, 1, v0
    ds_write_b16 v28, v57 offset:32768
    s_waitcnt lgkmcnt(0)
L_attn_q_done:
    s_nop 4
    s_barrier
    ds_read_b128 v[32:35], v6 offset:32768
    s_waitcnt lgkmcnt(0)
    s_waitcnt vmcnt(32)
    v_dot2_f32_bf16 v16, v64, v32, 0
    v_dot2_f32_bf16 v17, v68, v32, 0
    v_dot2_f32_bf16 v18, v72, v32, 0
    v_dot2_f32_bf16 v19, v76, v32, 0
    v_dot2_f32_bf16 v20, v80, v32, 0
    v_dot2_f32_bf16 v21, v84, v32, 0
    v_dot2_f32_bf16 v22, v88, v32, 0
    v_dot2_f32_bf16 v23, v92, v32, 0
    v_dot2_f32_bf16 v24, v96, v32, 0
    v_dot2_f32_bf16 v25, v100, v32, 0
    v_dot2_f32_bf16 v26, v104, v32, 0
    v_dot2_f32_bf16 v27, v108, v32, 0
    v_dot2_f32_bf16 v28, v112, v32, 0
    v_dot2_f32_bf16 v29, v116, v32, 0
    v_dot2_f32_bf16 v30, v120, v32, 0
    v_dot2_f32_bf16 v31, v124, v32, 0
    v_dot2c_f32_bf16 v16, v65, v33
    v_dot2c_f32_bf16 v17, v69, v33
    v_dot2c_f32_bf16 v18, v73, v33
    v_dot2c_f32_bf16 v19, v77, v33
    v_dot2c_f32_bf16 v20, v81, v33
    v_dot2c_f32_bf16 v21, v85, v33
    v_dot2c_f32_bf16 v22, v89, v33
    v_dot2c_f32_bf16 v23, v93, v33
    v_dot2c_f32_bf16 v24, v97, v33
    v_dot2c_f32_bf16 v25, v101, v33
    v_dot2c_f32_bf16 v26, v105, v33
    v_dot2c_f32_bf16 v27, v109, v33
    v_dot2c_f32_bf16 v28, v113, v33
    v_dot2c_f32_bf16 v29, v117, v33
    v_dot2c_f32_bf16 v30, v121, v33
    v_dot2c_f32_bf16 v31, v125, v33
    v_dot2c_f32_bf16 v16, v66, v34
    v_dot2c_f32_bf16 v17, v70, v34
    v_dot2c_f32_bf16 v18, v74, v34
    v_dot2c_f32_bf16 v19, v78, v34
    v_dot2c_f32_bf16 v20, v82, v34
    v_dot2c_f32_bf16 v21, v86, v34
    v_dot2c_f32_bf16 v22, v90, v34
    v_dot2c_f32_bf16 v23, v94, v34
    v_dot2c_f32_bf16 v24, v98, v34
    v_dot2c_f32_bf16 v25, v102, v34
    v_dot2c_f32_bf16 v26, v106, v34
    v_dot2c_f32_bf16 v27, v110, v34
    v_dot2c_f32_bf16 v28, v114, v34
    v_dot2c_f32_bf16 v29, v118, v34
    v_dot2c_f32_bf16 v30, v122, v34
    v_dot2c_f32_bf16 v31, v126, v34
    v_dot2c_f32_bf16 v16, v67, v35
    v_dot2c_f32_bf16 v17, v71, v35
    v_dot2c_f32_bf16 v18, v75, v35
    v_dot2c_f32_bf16 v19, v79, v35
    v_dot2c_f32_bf16 v20, v83, v35
    v_dot2c_f32_bf16 v21, v87, v35
    v_dot2c_f32_bf16 v22, v91, v35
    v_dot2c_f32_bf16 v23, v95, v35
    v_dot2c_f32_bf16 v24, v99, v35
    v_dot2c_f32_bf16 v25, v103, v35
    v_dot2c_f32_bf16 v26, v107, v35
    v_dot2c_f32_bf16 v27, v111, v35
    v_dot2c_f32_bf16 v28, v115, v35
    v_dot2c_f32_bf16 v29, v119, v35
    v_dot2c_f32_bf16 v30, v123, v35
    v_dot2c_f32_bf16 v31, v127, v35
    s_mov_b32 s40, 0x60000
    buffer_load_dwordx4 v[64:67], v2, s[8:11], s40 offen offset:0 nt
    buffer_load_dwordx4 v[68:71], v2, s[8:11], s40 offen offset:1024 nt
    buffer_load_dwordx4 v[72:75], v2, s[8:11], s40 offen offset:2048 nt
    buffer_load_dwordx4 v[76:79], v2, s[8:11], s40 offen offset:3072 nt
    s_mov_b32 s40, 0x61000
    buffer_load_dwordx4 v[80:83], v2, s[8:11], s40 offen offset:0 nt
    buffer_load_dwordx4 v[84:87], v2, s[8:11], s40 offen offset:1024 nt
    buffer_load_dwordx4 v[88:91], v2, s[8:11], s40 offen offset:2048 nt
    buffer_load_dwordx4 v[92:95], v2, s[8:11], s40 offen offset:3072 nt
    s_mov_b32 s40, 0x62000
    buffer_load_dwordx4 v[96:99], v2, s[8:11], s40 offen offset:0 nt
    buffer_load_dwordx4 v[100:103], v2, s[8:11], s40 offen offset:1024 nt
    buffer_load_dwordx4 v[104:107], v2, s[8:11], s40 offen offset:2048 nt
    buffer_load_dwordx4 v[108:111], v2, s[8:11], s40 offen offset:3072 nt
    s_mov_b32 s40, 0x63000
    buffer_load_dwordx4 v[112:115], v2, s[8:11], s40 offen offset:0 nt
    buffer_load_dwordx4 v[116:119], v2, s[8:11], s40 offen offset:1024 nt
    buffer_load_dwordx4 v[120:123], v2, s[8:11], s40 offen offset:2048 nt
    buffer_load_dwordx4 v[124:127], v2, s[8:11], s40 offen offset:3072 nt
    v_add_f32_dpp v16, v16, v16 row_ror:8 row_mask:0xf bank_mask:0x3
    v_add_f32_dpp v16, v24, v24 row_ror:8 row_mask:0xf bank_mask:0xc
    v_add_f32_dpp v17, v17, v17 row_ror:8 row_mask:0xf bank_mask:0x3
    v_add_f32_dpp v17, v25, v25 row_ror:8 row_mask:0xf bank_mask:0xc
    v_add_f32_dpp v18, v18, v18 row_ror:8 row_mask:0xf bank_mask:0x3
    v_add_f32_dpp v18, v26, v26 row_ror:8 row_mask:0xf bank_mask:0xc
    v_add_f32_dpp v19, v19, v19 row_ror:8 row_mask:0xf bank_mask:0x3
    v_add_f32_dpp v19, v27, v27 row_ror:8 row_mask:0xf bank_mask:0xc
    v_add_f32_dpp v20, v20, v20 row_ror:8 row_mask:0xf bank_mask:0x3
    v_add_f32_dpp v20, v28, v28 row_ror:8 row_mask:0xf bank_mask:0xc
    v_add_f32_dpp v21, v21, v21 row_ror:8 row_mask:0xf bank_mask:0x3
    v_add_f32_dpp v21, v29, v29 row_ror:8 row_mask:0xf bank_mask:0xc
    v_add_f32_dpp v22, v22, v22 row_ror:8 row_mask:0xf bank_mask:0x3
    v_add_f32_dpp v22, v30, v30 row_ror:8 row_mask:0xf bank_mask:0xc
    v_add_f32_dpp v23, v23, v23 row_ror:8 row_mask:0xf bank_mask:0x3
    v_add_f32_dpp v23, v31, v31 row_ror:8 row_mask:0xf bank_mask:0xc
    v_add_f32_dpp v16, v16, v16 row_half_mirror row_mask:0xf bank_mask:0x5
    v_add_f32_dpp v16, v20, v20 row_half_mirror row_mask:0xf bank_mask:0xa
    v_add_f32_dpp v17, v17, v17 row_half_mirror row_mask:0xf bank_mask:0x5
    v_add_f32_dpp v17, v21, v21 row_half_mirror row_mask:0xf bank_mask:0xa
    v_add_f32_dpp v18, v18, v18 row_half_mirror row_mask:0xf bank_mask:0x5
    v_add_f32_dpp v18, v22, v22 row_half_mirror row_mask:0xf bank_mask:0xa
    v_add_f32_dpp v19, v19, v19 row_half_mirror row_mask:0xf bank_mask:0x5
    v_add_f32_dpp v19, v23, v23 row_half_mirror row_mask:0xf bank_mask:0xa
    v_add_f32_dpp v16, v16, v16 quad_perm:[1,0,3,2] row_mask:0xf bank_mask:0xf
    v_add_f32_dpp v17, v17, v17 quad_perm:[1,0,3,2] row_mask:0xf bank_mask:0xf
    v_add_f32_dpp v18, v18, v18 quad_perm:[1,0,3,2] row_mask:0xf bank_mask:0xf
    v_add_f32_dpp v19, v19, v19 quad_perm:[1,0,3,2] row_mask:0xf bank_mask:0xf
    v_add_f32_dpp v16, v16, v16 quad_perm:[2,3,0,1] row_mask:0xf bank_mask:0xf
    v_add_f32_dpp v17, v17, v17 quad_perm:[2,3,0,1] row_mask:0xf bank_mask:0xf
    v_add_f32_dpp v18, v18, v18 quad_perm:[2,3,0,1] row_mask:0xf bank_mask:0xf
    v_add_f32_dpp v19, v19, v19 quad_perm:[2,3,0,1] row_mask:0xf bank_mask:0xf
    v_cndmask_b32 v36, v16, v17, s[44:45]
    v_cndmask_b32 v36, v36, v18, s[46:47]
    v_cndmask_b32 v36, v36, v19, s[48:49]
    v_cvt_pk_bf16_f32 v36, v36, v36
    v_lshlrev_b32 v36, 16, v36
    v_mul_f32 v36, 0x3db504f3, v36
    v_cvt_pk_bf16_f32 v36, v36, v36
    v_lshlrev_b32 v36, 16, v36
    s_waitcnt vmcnt(32)
    v_dot2_f32_bf16 v16, v128, v32, 0
    v_dot2_f32_bf16 v17, v132, v32, 0
    v_dot2_f32_bf16 v18, v136, v32, 0
    v_dot2_f32_bf16 v19, v140, v32, 0
    v_dot2_f32_bf16 v20, v144, v32, 0
    v_dot2_f32_bf16 v21, v148, v32, 0
    v_dot2_f32_bf16 v22, v152, v32, 0
    v_dot2_f32_bf16 v23, v156, v32, 0
    v_dot2_f32_bf16 v24, v160, v32, 0
    v_dot2_f32_bf16 v25, v164, v32, 0
    v_dot2_f32_bf16 v26, v168, v32, 0
    v_dot2_f32_bf16 v27, v172, v32, 0
    v_dot2_f32_bf16 v28, v176, v32, 0
    v_dot2_f32_bf16 v29, v180, v32, 0
    v_dot2_f32_bf16 v30, v184, v32, 0
    v_dot2_f32_bf16 v31, v188, v32, 0
    v_dot2c_f32_bf16 v16, v129, v33
    v_dot2c_f32_bf16 v17, v133, v33
    v_dot2c_f32_bf16 v18, v137, v33
    v_dot2c_f32_bf16 v19, v141, v33
    v_dot2c_f32_bf16 v20, v145, v33
    v_dot2c_f32_bf16 v21, v149, v33
    v_dot2c_f32_bf16 v22, v153, v33
    v_dot2c_f32_bf16 v23, v157, v33
    v_dot2c_f32_bf16 v24, v161, v33
    v_dot2c_f32_bf16 v25, v165, v33
    v_dot2c_f32_bf16 v26, v169, v33
    v_dot2c_f32_bf16 v27, v173, v33
    v_dot2c_f32_bf16 v28, v177, v33
    v_dot2c_f32_bf16 v29, v181, v33
    v_dot2c_f32_bf16 v30, v185, v33
    v_dot2c_f32_bf16 v31, v189, v33
    v_dot2c_f32_bf16 v16, v130, v34
    v_dot2c_f32_bf16 v17, v134, v34
    v_dot2c_f32_bf16 v18, v138, v34
    v_dot2c_f32_bf16 v19, v142, v34
    v_dot2c_f32_bf16 v20, v146, v34
    v_dot2c_f32_bf16 v21, v150, v34
    v_dot2c_f32_bf16 v22, v154, v34
    v_dot2c_f32_bf16 v23, v158, v34
    v_dot2c_f32_bf16 v24, v162, v34
    v_dot2c_f32_bf16 v25, v166, v34
    v_dot2c_f32_bf16 v26, v170, v34
    v_dot2c_f32_bf16 v27, v174, v34
    v_dot2c_f32_bf16 v28, v178, v34
    v_dot2c_f32_bf16 v29, v182, v34
    v_dot2c_f32_bf16 v30, v186, v34
    v_dot2c_f32_bf16 v31, v190, v34
    v_dot2c_f32_bf16 v16, v131, v35
    v_dot2c_f32_bf16 v17, v135, v35
    v_dot2c_f32_bf16 v18, v139, v35
    v_dot2c_f32_bf16 v19, v143, v35
    v_dot2c_f32_bf16 v20, v147, v35
    v_dot2c_f32_bf16 v21, v151, v35
    v_dot2c_f32_bf16 v22, v155, v35
    v_dot2c_f32_bf16 v23, v159, v35
    v_dot2c_f32_bf16 v24, v163, v35
    v_dot2c_f32_bf16 v25, v167, v35
    v_dot2c_f32_bf16 v26, v171, v35
    v_dot2c_f32_bf16 v27, v175, v35
    v_dot2c_f32_bf16 v28, v179, v35
    v_dot2c_f32_bf16 v29, v183, v35
    v_dot2c_f32_bf16 v30, v187, v35
    v_dot2c_f32_bf16 v31, v191, v35
    s_mov_b32 s40, 0x0
    buffer_load_dwordx4 v[128:131], v2, s[12:15], s40 offen offset:0 nt
    buffer_load_dwordx4 v[132:135], v2, s[12:15], s40 offen offset:1024 nt
    buffer_load_dwordx4 v[136:139], v2, s[12:15], s40 offen offset:2048 nt
    buffer_load_dwordx4 v[140:143], v2, s[12:15], s40 offen offset:3072 nt
    s_mov_b32 s40, 0x1000
    buffer_load_dwordx4 v[144:147], v2, s[12:15], s40 offen offset:0 nt
    buffer_load_dwordx4 v[148:151], v2, s[12:15], s40 offen offset:1024 nt
    buffer_load_dwordx4 v[152:155], v2, s[12:15], s40 offen offset:2048 nt
    buffer_load_dwordx4 v[156:159], v2, s[12:15], s40 offen offset:3072 nt
    s_mov_b32 s40, 0x2000
    buffer_load_dwordx4 v[160:163], v2, s[12:15], s40 offen offset:0 nt
    buffer_load_dwordx4 v[164:167], v2, s[12:15], s40 offen offset:1024 nt
    buffer_load_dwordx4 v[168:171], v2, s[12:15], s40 offen offset:2048 nt
    buffer_load_dwordx4 v[172:175], v2, s[12:15], s40 offen offset:3072 nt
    s_mov_b32 s40, 0x3000
    buffer_load_dwordx4 v[176:179], v2, s[12:15], s40 offen offset:0 nt
    buffer_load_dwordx4 v[180:183], v2, s[12:15], s40 offen offset:1024 nt
    buffer_load_dwordx4 v[184:187], v2, s[12:15], s40 offen offset:2048 nt
    buffer_load_dwordx4 v[188:191], v2, s[12:15], s40 offen offset:3072 nt
    v_add_f32_dpp v16, v16, v16 row_ror:8 row_mask:0xf bank_mask:0x3
    v_add_f32_dpp v16, v24, v24 row_ror:8 row_mask:0xf bank_mask:0xc
    v_add_f32_dpp v17, v17, v17 row_ror:8 row_mask:0xf bank_mask:0x3
    v_add_f32_dpp v17, v25, v25 row_ror:8 row_mask:0xf bank_mask:0xc
    v_add_f32_dpp v18, v18, v18 row_ror:8 row_mask:0xf bank_mask:0x3
    v_add_f32_dpp v18, v26, v26 row_ror:8 row_mask:0xf bank_mask:0xc
    v_add_f32_dpp v19, v19, v19 row_ror:8 row_mask:0xf bank_mask:0x3
    v_add_f32_dpp v19, v27, v27 row_ror:8 row_mask:0xf bank_mask:0xc
    v_add_f32_dpp v20, v20, v20 row_ror:8 row_mask:0xf bank_mask:0x3
    v_add_f32_dpp v20, v28, v28 row_ror:8 row_mask:0xf bank_mask:0xc
    v_add_f32_dpp v21, v21, v21 row_ror:8 row_mask:0xf bank_mask:0x3
    v_add_f32_dpp v21, v29, v29 row_ror:8 row_mask:0xf bank_mask:0xc
    v_add_f32_dpp v22, v22, v22 row_ror:8 row_mask:0xf bank_mask:0x3
    v_add_f32_dpp v22, v30, v30 row_ror:8 row_mask:0xf bank_mask:0xc
    v_add_f32_dpp v23, v23, v23 row_ror:8 row_mask:0xf bank_mask:0x3
    v_add_f32_dpp v23, v31, v31 row_ror:8 row_mask:0xf bank_mask:0xc
    v_add_f32_dpp v16, v16, v16 row_half_mirror row_mask:0xf bank_mask:0x5
    v_add_f32_dpp v16, v20, v20 row_half_mirror row_mask:0xf bank_mask:0xa
    v_add_f32_dpp v17, v17, v17 row_half_mirror row_mask:0xf bank_mask:0x5
    v_add_f32_dpp v17, v21, v21 row_half_mirror row_mask:0xf bank_mask:0xa
    v_add_f32_dpp v18, v18, v18 row_half_mirror row_mask:0xf bank_mask:0x5
    v_add_f32_dpp v18, v22, v22 row_half_mirror row_mask:0xf bank_mask:0xa
    v_add_f32_dpp v19, v19, v19 row_half_mirror row_mask:0xf bank_mask:0x5
    v_add_f32_dpp v19, v23, v23 row_half_mirror row_mask:0xf bank_mask:0xa
    v_add_f32_dpp v16, v16, v16 quad_perm:[1,0,3,2] row_mask:0xf bank_mask:0xf
    v_add_f32_dpp v17, v17, v17 quad_perm:[1,0,3,2] row_mask:0xf bank_mask:0xf
    v_add_f32_dpp v18, v18, v18 quad_perm:[1,0,3,2] row_mask:0xf bank_mask:0xf
    v_add_f32_dpp v19, v19, v19 quad_perm:[1,0,3,2] row_mask:0xf bank_mask:0xf
    v_add_f32_dpp v16, v16, v16 quad_perm:[2,3,0,1] row_mask:0xf bank_mask:0xf
    v_add_f32_dpp v17, v17, v17 quad_perm:[2,3,0,1] row_mask:0xf bank_mask:0xf
    v_add_f32_dpp v18, v18, v18 quad_perm:[2,3,0,1] row_mask:0xf bank_mask:0xf
    v_add_f32_dpp v19, v19, v19 quad_perm:[2,3,0,1] row_mask:0xf bank_mask:0xf
    v_cndmask_b32 v37, v16, v17, s[44:45]
    v_cndmask_b32 v37, v37, v18, s[46:47]
    v_cndmask_b32 v37, v37, v19, s[48:49]
    v_cvt_pk_bf16_f32 v37, v37, v37
    v_lshlrev_b32 v37, 16, v37
    v_mul_f32 v37, 0x3db504f3, v37
    v_cvt_pk_bf16_f32 v37, v37, v37
    v_lshlrev_b32 v37, 16, v37
    s_waitcnt vmcnt(32)
    v_dot2_f32_bf16 v16, v192, v32, 0
    v_dot2_f32_bf16 v17, v196, v32, 0
    v_dot2_f32_bf16 v18, v200, v32, 0
    v_dot2_f32_bf16 v19, v204, v32, 0
    v_dot2_f32_bf16 v20, v208, v32, 0
    v_dot2_f32_bf16 v21, v212, v32, 0
    v_dot2_f32_bf16 v22, v216, v32, 0
    v_dot2_f32_bf16 v23, v220, v32, 0
    v_dot2_f32_bf16 v24, v224, v32, 0
    v_dot2_f32_bf16 v25, v228, v32, 0
    v_dot2_f32_bf16 v26, v232, v32, 0
    v_dot2_f32_bf16 v27, v236, v32, 0
    v_dot2_f32_bf16 v28, v240, v32, 0
    v_dot2_f32_bf16 v29, v244, v32, 0
    v_dot2_f32_bf16 v30, v248, v32, 0
    v_dot2_f32_bf16 v31, v252, v32, 0
    v_dot2c_f32_bf16 v16, v193, v33
    v_dot2c_f32_bf16 v17, v197, v33
    v_dot2c_f32_bf16 v18, v201, v33
    v_dot2c_f32_bf16 v19, v205, v33
    v_dot2c_f32_bf16 v20, v209, v33
    v_dot2c_f32_bf16 v21, v213, v33
    v_dot2c_f32_bf16 v22, v217, v33
    v_dot2c_f32_bf16 v23, v221, v33
    v_dot2c_f32_bf16 v24, v225, v33
    v_dot2c_f32_bf16 v25, v229, v33
    v_dot2c_f32_bf16 v26, v233, v33
    v_dot2c_f32_bf16 v27, v237, v33
    v_dot2c_f32_bf16 v28, v241, v33
    v_dot2c_f32_bf16 v29, v245, v33
    v_dot2c_f32_bf16 v30, v249, v33
    v_dot2c_f32_bf16 v31, v253, v33
    v_dot2c_f32_bf16 v16, v194, v34
    v_dot2c_f32_bf16 v17, v198, v34
    v_dot2c_f32_bf16 v18, v202, v34
    v_dot2c_f32_bf16 v19, v206, v34
    v_dot2c_f32_bf16 v20, v210, v34
    v_dot2c_f32_bf16 v21, v214, v34
    v_dot2c_f32_bf16 v22, v218, v34
    v_dot2c_f32_bf16 v23, v222, v34
    v_dot2c_f32_bf16 v24, v226, v34
    v_dot2c_f32_bf16 v25, v230, v34
    v_dot2c_f32_bf16 v26, v234, v34
    v_dot2c_f32_bf16 v27, v238, v34
    v_dot2c_f32_bf16 v28, v242, v34
    v_dot2c_f32_bf16 v29, v246, v34
    v_dot2c_f32_bf16 v30, v250, v34
    v_dot2c_f32_bf16 v31, v254, v34
    v_dot2c_f32_bf16 v16, v195, v35
    v_dot2c_f32_bf16 v17, v199, v35
    v_dot2c_f32_bf16 v18, v203, v35
    v_dot2c_f32_bf16 v19, v207, v35
    v_dot2c_f32_bf16 v20, v211, v35
    v_dot2c_f32_bf16 v21, v215, v35
    v_dot2c_f32_bf16 v22, v219, v35
    v_dot2c_f32_bf16 v23, v223, v35
    v_dot2c_f32_bf16 v24, v227, v35
    v_dot2c_f32_bf16 v25, v231, v35
    v_dot2c_f32_bf16 v26, v235, v35
    v_dot2c_f32_bf16 v27, v239, v35
    v_dot2c_f32_bf16 v28, v243, v35
    v_dot2c_f32_bf16 v29, v247, v35
    v_dot2c_f32_bf16 v30, v251, v35
    v_dot2c_f32_bf16 v31, v255, v35
    s_mov_b32 s40, 0x20000
    buffer_load_dwordx4 v[192:195], v2, s[12:15], s40 offen offset:0 nt
    buffer_load_dwordx4 v[196:199], v2, s[12:15], s40 offen offset:1024 nt
    buffer_load_dwordx4 v[200:203], v2, s[12:15], s40 offen offset:2048 nt
    buffer_load_dwordx4 v[204:207], v2, s[12:15], s40 offen offset:3072 nt
    s_mov_b32 s40, 0x21000
    buffer_load_dwordx4 v[208:211], v2, s[12:15], s40 offen offset:0 nt
    buffer_load_dwordx4 v[212:215], v2, s[12:15], s40 offen offset:1024 nt
    buffer_load_dwordx4 v[216:219], v2, s[12:15], s40 offen offset:2048 nt
    buffer_load_dwordx4 v[220:223], v2, s[12:15], s40 offen offset:3072 nt
    s_mov_b32 s40, 0x22000
    buffer_load_dwordx4 v[224:227], v2, s[12:15], s40 offen offset:0 nt
    buffer_load_dwordx4 v[228:231], v2, s[12:15], s40 offen offset:1024 nt
    buffer_load_dwordx4 v[232:235], v2, s[12:15], s40 offen offset:2048 nt
    buffer_load_dwordx4 v[236:239], v2, s[12:15], s40 offen offset:3072 nt
    s_mov_b32 s40, 0x23000
    buffer_load_dwordx4 v[240:243], v2, s[12:15], s40 offen offset:0 nt
    buffer_load_dwordx4 v[244:247], v2, s[12:15], s40 offen offset:1024 nt
    buffer_load_dwordx4 v[248:251], v2, s[12:15], s40 offen offset:2048 nt
    buffer_load_dwordx4 v[252:255], v2, s[12:15], s40 offen offset:3072 nt
    v_add_f32_dpp v16, v16, v16 row_ror:8 row_mask:0xf bank_mask:0x3
    v_add_f32_dpp v16, v24, v24 row_ror:8 row_mask:0xf bank_mask:0xc
    v_add_f32_dpp v17, v17, v17 row_ror:8 row_mask:0xf bank_mask:0x3
    v_add_f32_dpp v17, v25, v25 row_ror:8 row_mask:0xf bank_mask:0xc
    v_add_f32_dpp v18, v18, v18 row_ror:8 row_mask:0xf bank_mask:0x3
    v_add_f32_dpp v18, v26, v26 row_ror:8 row_mask:0xf bank_mask:0xc
    v_add_f32_dpp v19, v19, v19 row_ror:8 row_mask:0xf bank_mask:0x3
    v_add_f32_dpp v19, v27, v27 row_ror:8 row_mask:0xf bank_mask:0xc
    v_add_f32_dpp v20, v20, v20 row_ror:8 row_mask:0xf bank_mask:0x3
    v_add_f32_dpp v20, v28, v28 row_ror:8 row_mask:0xf bank_mask:0xc
    v_add_f32_dpp v21, v21, v21 row_ror:8 row_mask:0xf bank_mask:0x3
    v_add_f32_dpp v21, v29, v29 row_ror:8 row_mask:0xf bank_mask:0xc
    v_add_f32_dpp v22, v22, v22 row_ror:8 row_mask:0xf bank_mask:0x3
    v_add_f32_dpp v22, v30, v30 row_ror:8 row_mask:0xf bank_mask:0xc
    v_add_f32_dpp v23, v23, v23 row_ror:8 row_mask:0xf bank_mask:0x3
    v_add_f32_dpp v23, v31, v31 row_ror:8 row_mask:0xf bank_mask:0xc
    v_add_f32_dpp v16, v16, v16 row_half_mirror row_mask:0xf bank_mask:0x5
    v_add_f32_dpp v16, v20, v20 row_half_mirror row_mask:0xf bank_mask:0xa
    v_add_f32_dpp v17, v17, v17 row_half_mirror row_mask:0xf bank_mask:0x5
    v_add_f32_dpp v17, v21, v21 row_half_mirror row_mask:0xf bank_mask:0xa
    v_add_f32_dpp v18, v18, v18 row_half_mirror row_mask:0xf bank_mask:0x5
    v_add_f32_dpp v18, v22, v22 row_half_mirror row_mask:0xf bank_mask:0xa
    v_add_f32_dpp v19, v19, v19 row_half_mirror row_mask:0xf bank_mask:0x5
    v_add_f32_dpp v19, v23, v23 row_half_mirror row_mask:0xf bank_mask:0xa
    v_add_f32_dpp v16, v16, v16 quad_perm:[1,0,3,2] row_mask:0xf bank_mask:0xf
    v_add_f32_dpp v17, v17, v17 quad_perm:[1,0,3,2] row_mask:0xf bank_mask:0xf
    v_add_f32_dpp v18, v18, v18 quad_perm:[1,0,3,2] row_mask:0xf bank_mask:0xf
    v_add_f32_dpp v19, v19, v19 quad_perm:[1,0,3,2] row_mask:0xf bank_mask:0xf
    v_add_f32_dpp v16, v16, v16 quad_perm:[2,3,0,1] row_mask:0xf bank_mask:0xf
    v_add_f32_dpp v17, v17, v17 quad_perm:[2,3,0,1] row_mask:0xf bank_mask:0xf
    v_add_f32_dpp v18, v18, v18 quad_perm:[2,3,0,1] row_mask:0xf bank_mask:0xf
    v_add_f32_dpp v19, v19, v19 quad_perm:[2,3,0,1] row_mask:0xf bank_mask:0xf
    v_cndmask_b32 v38, v16, v17, s[44:45]
    v_cndmask_b32 v38, v38, v18, s[46:47]
    v_cndmask_b32 v38, v38, v19, s[48:49]
    v_cvt_pk_bf16_f32 v38, v38, v38
    v_lshlrev_b32 v38, 16, v38
    v_mul_f32 v38, 0x3db504f3, v38
    v_cvt_pk_bf16_f32 v38, v38, v38
    v_lshlrev_b32 v38, 16, v38
    s_waitcnt vmcnt(32)
    v_dot2_f32_bf16 v16, v64, v32, 0
    v_dot2_f32_bf16 v17, v68, v32, 0
    v_dot2_f32_bf16 v18, v72, v32, 0
    v_dot2_f32_bf16 v19, v76, v32, 0
    v_dot2_f32_bf16 v20, v80, v32, 0
    v_dot2_f32_bf16 v21, v84, v32, 0
    v_dot2_f32_bf16 v22, v88, v32, 0
    v_dot2_f32_bf16 v23, v92, v32, 0
    v_dot2_f32_bf16 v24, v96, v32, 0
    v_dot2_f32_bf16 v25, v100, v32, 0
    v_dot2_f32_bf16 v26, v104, v32, 0
    v_dot2_f32_bf16 v27, v108, v32, 0
    v_dot2_f32_bf16 v28, v112, v32, 0
    v_dot2_f32_bf16 v29, v116, v32, 0
    v_dot2_f32_bf16 v30, v120, v32, 0
    v_dot2_f32_bf16 v31, v124, v32, 0
    v_dot2c_f32_bf16 v16, v65, v33
    v_dot2c_f32_bf16 v17, v69, v33
    v_dot2c_f32_bf16 v18, v73, v33
    v_dot2c_f32_bf16 v19, v77, v33
    v_dot2c_f32_bf16 v20, v81, v33
    v_dot2c_f32_bf16 v21, v85, v33
    v_dot2c_f32_bf16 v22, v89, v33
    v_dot2c_f32_bf16 v23, v93, v33
    v_dot2c_f32_bf16 v24, v97, v33
    v_dot2c_f32_bf16 v25, v101, v33
    v_dot2c_f32_bf16 v26, v105, v33
    v_dot2c_f32_bf16 v27, v109, v33
    v_dot2c_f32_bf16 v28, v113, v33
    v_dot2c_f32_bf16 v29, v117, v33
    v_dot2c_f32_bf16 v30, v121, v33
    v_dot2c_f32_bf16 v31, v125, v33
    v_dot2c_f32_bf16 v16, v66, v34
    v_dot2c_f32_bf16 v17, v70, v34
    v_dot2c_f32_bf16 v18, v74, v34
    v_dot2c_f32_bf16 v19, v78, v34
    v_dot2c_f32_bf16 v20, v82, v34
    v_dot2c_f32_bf16 v21, v86, v34
    v_dot2c_f32_bf16 v22, v90, v34
    v_dot2c_f32_bf16 v23, v94, v34
    v_dot2c_f32_bf16 v24, v98, v34
    v_dot2c_f32_bf16 v25, v102, v34
    v_dot2c_f32_bf16 v26, v106, v34
    v_dot2c_f32_bf16 v27, v110, v34
    v_dot2c_f32_bf16 v28, v114, v34
    v_dot2c_f32_bf16 v29, v118, v34
    v_dot2c_f32_bf16 v30, v122, v34
    v_dot2c_f32_bf16 v31, v126, v34
    v_dot2c_f32_bf16 v16, v67, v35
    v_dot2c_f32_bf16 v17, v71, v35
    v_dot2c_f32_bf16 v18, v75, v35
    v_dot2c_f32_bf16 v19, v79, v35
    v_dot2c_f32_bf16 v20, v83, v35
    v_dot2c_f32_bf16 v21, v87, v35
    v_dot2c_f32_bf16 v22, v91, v35
    v_dot2c_f32_bf16 v23, v95, v35
    v_dot2c_f32_bf16 v24, v99, v35
    v_dot2c_f32_bf16 v25, v103, v35
    v_dot2c_f32_bf16 v26, v107, v35
    v_dot2c_f32_bf16 v27, v111, v35
    v_dot2c_f32_bf16 v28, v115, v35
    v_dot2c_f32_bf16 v29, v119, v35
    v_dot2c_f32_bf16 v30, v123, v35
    v_dot2c_f32_bf16 v31, v127, v35
    s_mov_b32 s40, 0x40000
    buffer_load_dwordx4 v[64:67], v2, s[12:15], s40 offen offset:0 nt
    buffer_load_dwordx4 v[68:71], v2, s[12:15], s40 offen offset:1024 nt
    buffer_load_dwordx4 v[72:75], v2, s[12:15], s40 offen offset:2048 nt
    buffer_load_dwordx4 v[76:79], v2, s[12:15], s40 offen offset:3072 nt
    s_mov_b32 s40, 0x41000
    buffer_load_dwordx4 v[80:83], v2, s[12:15], s40 offen offset:0 nt
    buffer_load_dwordx4 v[84:87], v2, s[12:15], s40 offen offset:1024 nt
    buffer_load_dwordx4 v[88:91], v2, s[12:15], s40 offen offset:2048 nt
    buffer_load_dwordx4 v[92:95], v2, s[12:15], s40 offen offset:3072 nt
    s_mov_b32 s40, 0x42000
    buffer_load_dwordx4 v[96:99], v2, s[12:15], s40 offen offset:0 nt
    buffer_load_dwordx4 v[100:103], v2, s[12:15], s40 offen offset:1024 nt
    buffer_load_dwordx4 v[104:107], v2, s[12:15], s40 offen offset:2048 nt
    buffer_load_dwordx4 v[108:111], v2, s[12:15], s40 offen offset:3072 nt
    s_mov_b32 s40, 0x43000
    buffer_load_dwordx4 v[112:115], v2, s[12:15], s40 offen offset:0 nt
    buffer_load_dwordx4 v[116:119], v2, s[12:15], s40 offen offset:1024 nt
    buffer_load_dwordx4 v[120:123], v2, s[12:15], s40 offen offset:2048 nt
    buffer_load_dwordx4 v[124:127], v2, s[12:15], s40 offen offset:3072 nt
    v_add_f32_dpp v16, v16, v16 row_ror:8 row_mask:0xf bank_mask:0x3
    v_add_f32_dpp v16, v24, v24 row_ror:8 row_mask:0xf bank_mask:0xc
    v_add_f32_dpp v17, v17, v17 row_ror:8 row_mask:0xf bank_mask:0x3
    v_add_f32_dpp v17, v25, v25 row_ror:8 row_mask:0xf bank_mask:0xc
    v_add_f32_dpp v18, v18, v18 row_ror:8 row_mask:0xf bank_mask:0x3
    v_add_f32_dpp v18, v26, v26 row_ror:8 row_mask:0xf bank_mask:0xc
    v_add_f32_dpp v19, v19, v19 row_ror:8 row_mask:0xf bank_mask:0x3
    v_add_f32_dpp v19, v27, v27 row_ror:8 row_mask:0xf bank_mask:0xc
    v_add_f32_dpp v20, v20, v20 row_ror:8 row_mask:0xf bank_mask:0x3
    v_add_f32_dpp v20, v28, v28 row_ror:8 row_mask:0xf bank_mask:0xc
    v_add_f32_dpp v21, v21, v21 row_ror:8 row_mask:0xf bank_mask:0x3
    v_add_f32_dpp v21, v29, v29 row_ror:8 row_mask:0xf bank_mask:0xc
    v_add_f32_dpp v22, v22, v22 row_ror:8 row_mask:0xf bank_mask:0x3
    v_add_f32_dpp v22, v30, v30 row_ror:8 row_mask:0xf bank_mask:0xc
    v_add_f32_dpp v23, v23, v23 row_ror:8 row_mask:0xf bank_mask:0x3
    v_add_f32_dpp v23, v31, v31 row_ror:8 row_mask:0xf bank_mask:0xc
    v_add_f32_dpp v16, v16, v16 row_half_mirror row_mask:0xf bank_mask:0x5
    v_add_f32_dpp v16, v20, v20 row_half_mirror row_mask:0xf bank_mask:0xa
    v_add_f32_dpp v17, v17, v17 row_half_mirror row_mask:0xf bank_mask:0x5
    v_add_f32_dpp v17, v21, v21 row_half_mirror row_mask:0xf bank_mask:0xa
    v_add_f32_dpp v18, v18, v18 row_half_mirror row_mask:0xf bank_mask:0x5
    v_add_f32_dpp v18, v22, v22 row_half_mirror row_mask:0xf bank_mask:0xa
    v_add_f32_dpp v19, v19, v19 row_half_mirror row_mask:0xf bank_mask:0x5
    v_add_f32_dpp v19, v23, v23 row_half_mirror row_mask:0xf bank_mask:0xa
    v_add_f32_dpp v16, v16, v16 quad_perm:[1,0,3,2] row_mask:0xf bank_mask:0xf
    v_add_f32_dpp v17, v17, v17 quad_perm:[1,0,3,2] row_mask:0xf bank_mask:0xf
    v_add_f32_dpp v18, v18, v18 quad_perm:[1,0,3,2] row_mask:0xf bank_mask:0xf
    v_add_f32_dpp v19, v19, v19 quad_perm:[1,0,3,2] row_mask:0xf bank_mask:0xf
    v_add_f32_dpp v16, v16, v16 quad_perm:[2,3,0,1] row_mask:0xf bank_mask:0xf
    v_add_f32_dpp v17, v17, v17 quad_perm:[2,3,0,1] row_mask:0xf bank_mask:0xf
    v_add_f32_dpp v18, v18, v18 quad_perm:[2,3,0,1] row_mask:0xf bank_mask:0xf
    v_add_f32_dpp v19, v19, v19 quad_perm:[2,3,0,1] row_mask:0xf bank_mask:0xf
    v_cndmask_b32 v39, v16, v17, s[44:45]
    v_cndmask_b32 v39, v39, v18, s[46:47]
    v_cndmask_b32 v39, v39, v19, s[48:49]
    v_cvt_pk_bf16_f32 v39, v39, v39
    v_lshlrev_b32 v39, 16, v39
    v_mul_f32 v39, 0x3db504f3, v39
    v_cvt_pk_bf16_f32 v39, v39, v39
    v_lshlrev_b32 v39, 16, v39
    v_max3_f32 v57, v36, v37, v38
    v_max_f32 v57, v57, v39
    s_nop 1
    v_max_f32_dpp v57, v57, v57 row_ror:8 row_mask:0xf bank_mask:0xf
    s_nop 1
    v_max_f32_dpp v57, v57, v57 row_ror:4 row_mask:0xf bank_mask:0xf
    s_nop 1
    v_max_f32_dpp v57, v57, v57 row_ror:2 row_mask:0xf bank_mask:0xf
    s_nop 1
    v_max_f32_dpp v57, v57, v57 row_ror:1 row_mask:0xf bank_mask:0xf
    v_mov_b32 v58, v57
    s_nop 1
    v_permlane16_swap_b32 v57, v58
    v_max_f32 v57, v57, v58
    v_mov_b32 v58, v57
    s_nop 1
    v_permlane32_swap_b32 v57, v58
    v_max_f32 v57, v57, v58
    v_mov_b32 v56, 0
    v_sub_f32 v58, v36, v57
    v_mul_f32 v58, 0x3fb8aa3b, v58
    v_exp_f32 v58, v58
    s_nop 0
    v_cvt_pk_bf16_f32 v40, v58, 0
    v_cvt_pk_bf16_f32 v41, 0, v58
    v_add_f32 v56, v56, v41
    v_sub_f32 v58, v37, v57
    v_mul_f32 v58, 0x3fb8aa3b, v58
    v_exp_f32 v58, v58
    s_nop 0
    v_cvt_pk_bf16_f32 v42, v58, 0
    v_cvt_pk_bf16_f32 v43, 0, v58
    v_add_f32 v56, v56, v43
    v_sub_f32 v58, v38, v57
    v_mul_f32 v58, 0x3fb8aa3b, v58
    v_exp_f32 v58, v58
    s_nop 0
    v_cvt_pk_bf16_f32 v44, v58, 0
    v_cvt_pk_bf16_f32 v45, 0, v58
    v_add_f32 v56, v56, v45
    v_sub_f32 v58, v39, v57
    v_mul_f32 v58, 0x3fb8aa3b, v58
    v_exp_f32 v58, v58
    s_nop 0
    v_cvt_pk_bf16_f32 v46, v58, 0
    v_cvt_pk_bf16_f32 v47, 0, v58
    v_add_f32 v56, v56, v47
    v_mov_b32 v48, 0
    v_mov_b32 v49, 0
    v_mov_b32 v50, 0
    v_mov_b32 v51, 0
    v_mov_b32 v52, 0
    v_mov_b32 v53, 0
    v_mov_b32 v54, 0
    v_mov_b32 v55, 0
    s_waitcnt vmcnt(32)
    v_dot2c_f32_bf16_dpp v48, v40, v128 row_newbcast:0 row_mask:0xf bank_mask:0xf
    v_dot2c_f32_bf16_dpp v49, v41, v128 row_newbcast:0 row_mask:0xf bank_mask:0xf
    v_dot2c_f32_bf16_dpp v50, v40, v129 row_newbcast:0 row_mask:0xf bank_mask:0xf
    v_dot2c_f32_bf16_dpp v51, v41, v129 row_newbcast:0 row_mask:0xf bank_mask:0xf
    v_dot2c_f32_bf16_dpp v52, v40, v130 row_newbcast:0 row_mask:0xf bank_mask:0xf
    v_dot2c_f32_bf16_dpp v53, v41, v130 row_newbcast:0 row_mask:0xf bank_mask:0xf
    v_dot2c_f32_bf16_dpp v54, v40, v131 row_newbcast:0 row_mask:0xf bank_mask:0xf
    v_dot2c_f32_bf16_dpp v55, v41, v131 row_newbcast:0 row_mask:0xf bank_mask:0xf
    v_dot2c_f32_bf16_dpp v48, v40, v132 row_newbcast:1 row_mask:0xf bank_mask:0xf
    v_dot2c_f32_bf16_dpp v49, v41, v132 row_newbcast:1 row_mask:0xf bank_mask:0xf
    v_dot2c_f32_bf16_dpp v50, v40, v133 row_newbcast:1 row_mask:0xf bank_mask:0xf
    v_dot2c_f32_bf16_dpp v51, v41, v133 row_newbcast:1 row_mask:0xf bank_mask:0xf
    v_dot2c_f32_bf16_dpp v52, v40, v134 row_newbcast:1 row_mask:0xf bank_mask:0xf
    v_dot2c_f32_bf16_dpp v53, v41, v134 row_newbcast:1 row_mask:0xf bank_mask:0xf
    v_dot2c_f32_bf16_dpp v54, v40, v135 row_newbcast:1 row_mask:0xf bank_mask:0xf
    v_dot2c_f32_bf16_dpp v55, v41, v135 row_newbcast:1 row_mask:0xf bank_mask:0xf
    v_dot2c_f32_bf16_dpp v48, v40, v136 row_newbcast:2 row_mask:0xf bank_mask:0xf
    v_dot2c_f32_bf16_dpp v49, v41, v136 row_newbcast:2 row_mask:0xf bank_mask:0xf
    v_dot2c_f32_bf16_dpp v50, v40, v137 row_newbcast:2 row_mask:0xf bank_mask:0xf
    v_dot2c_f32_bf16_dpp v51, v41, v137 row_newbcast:2 row_mask:0xf bank_mask:0xf
    v_dot2c_f32_bf16_dpp v52, v40, v138 row_newbcast:2 row_mask:0xf bank_mask:0xf
    v_dot2c_f32_bf16_dpp v53, v41, v138 row_newbcast:2 row_mask:0xf bank_mask:0xf
    v_dot2c_f32_bf16_dpp v54, v40, v139 row_newbcast:2 row_mask:0xf bank_mask:0xf
    v_dot2c_f32_bf16_dpp v55, v41, v139 row_newbcast:2 row_mask:0xf bank_mask:0xf
    v_dot2c_f32_bf16_dpp v48, v40, v140 row_newbcast:3 row_mask:0xf bank_mask:0xf
    v_dot2c_f32_bf16_dpp v49, v41, v140 row_newbcast:3 row_mask:0xf bank_mask:0xf
    v_dot2c_f32_bf16_dpp v50, v40, v141 row_newbcast:3 row_mask:0xf bank_mask:0xf
    v_dot2c_f32_bf16_dpp v51, v41, v141 row_newbcast:3 row_mask:0xf bank_mask:0xf
    v_dot2c_f32_bf16_dpp v52, v40, v142 row_newbcast:3 row_mask:0xf bank_mask:0xf
    v_dot2c_f32_bf16_dpp v53, v41, v142 row_newbcast:3 row_mask:0xf bank_mask:0xf
    v_dot2c_f32_bf16_dpp v54, v40, v143 row_newbcast:3 row_mask:0xf bank_mask:0xf
    v_dot2c_f32_bf16_dpp v55, v41, v143 row_newbcast:3 row_mask:0xf bank_mask:0xf
    v_dot2c_f32_bf16_dpp v48, v40, v144 row_newbcast:4 row_mask:0xf bank_mask:0xf
    v_dot2c_f32_bf16_dpp v49, v41, v144 row_newbcast:4 row_mask:0xf bank_mask:0xf
    v_dot2c_f32_bf16_dpp v50, v40, v145 row_newbcast:4 row_mask:0xf bank_mask:0xf
    v_dot2c_f32_bf16_dpp v51, v41, v145 row_newbcast:4 row_mask:0xf bank_mask:0xf
    v_dot2c_f32_bf16_dpp v52, v40, v146 row_newbcast:4 row_mask:0xf bank_mask:0xf
    v_dot2c_f32_bf16_dpp v53, v41, v146 row_newbcast:4 row_mask:0xf bank_mask:0xf
    v_dot2c_f32_bf16_dpp v54, v40, v147 row_newbcast:4 row_mask:0xf bank_mask:0xf
    v_dot2c_f32_bf16_dpp v55, v41, v147 row_newbcast:4 row_mask:0xf bank_mask:0xf
    v_dot2c_f32_bf16_dpp v48, v40, v148 row_newbcast:5 row_mask:0xf bank_mask:0xf
    v_dot2c_f32_bf16_dpp v49, v41, v148 row_newbcast:5 row_mask:0xf bank_mask:0xf
    v_dot2c_f32_bf16_dpp v50, v40, v149 row_newbcast:5 row_mask:0xf bank_mask:0xf
    v_dot2c_f32_bf16_dpp v51, v41, v149 row_newbcast:5 row_mask:0xf bank_mask:0xf
    v_dot2c_f32_bf16_dpp v52, v40, v150 row_newbcast:5 row_mask:0xf bank_mask:0xf
    v_dot2c_f32_bf16_dpp v53, v41, v150 row_newbcast:5 row_mask:0xf bank_mask:0xf
    v_dot2c_f32_bf16_dpp v54, v40, v151 row_newbcast:5 row_mask:0xf bank_mask:0xf
    v_dot2c_f32_bf16_dpp v55, v41, v151 row_newbcast:5 row_mask:0xf bank_mask:0xf
    v_dot2c_f32_bf16_dpp v48, v40, v152 row_newbcast:6 row_mask:0xf bank_mask:0xf
    v_dot2c_f32_bf16_dpp v49, v41, v152 row_newbcast:6 row_mask:0xf bank_mask:0xf
    v_dot2c_f32_bf16_dpp v50, v40, v153 row_newbcast:6 row_mask:0xf bank_mask:0xf
    v_dot2c_f32_bf16_dpp v51, v41, v153 row_newbcast:6 row_mask:0xf bank_mask:0xf
    v_dot2c_f32_bf16_dpp v52, v40, v154 row_newbcast:6 row_mask:0xf bank_mask:0xf
    v_dot2c_f32_bf16_dpp v53, v41, v154 row_newbcast:6 row_mask:0xf bank_mask:0xf
    v_dot2c_f32_bf16_dpp v54, v40, v155 row_newbcast:6 row_mask:0xf bank_mask:0xf
    v_dot2c_f32_bf16_dpp v55, v41, v155 row_newbcast:6 row_mask:0xf bank_mask:0xf
    v_dot2c_f32_bf16_dpp v48, v40, v156 row_newbcast:7 row_mask:0xf bank_mask:0xf
    v_dot2c_f32_bf16_dpp v49, v41, v156 row_newbcast:7 row_mask:0xf bank_mask:0xf
    v_dot2c_f32_bf16_dpp v50, v40, v157 row_newbcast:7 row_mask:0xf bank_mask:0xf
    v_dot2c_f32_bf16_dpp v51, v41, v157 row_newbcast:7 row_mask:0xf bank_mask:0xf
    v_dot2c_f32_bf16_dpp v52, v40, v158 row_newbcast:7 row_mask:0xf bank_mask:0xf
    v_dot2c_f32_bf16_dpp v53, v41, v158 row_newbcast:7 row_mask:0xf bank_mask:0xf
    v_dot2c_f32_bf16_dpp v54, v40, v159 row_newbcast:7 row_mask:0xf bank_mask:0xf
    v_dot2c_f32_bf16_dpp v55, v41, v159 row_newbcast:7 row_mask:0xf bank_mask:0xf
    v_dot2c_f32_bf16_dpp v48, v40, v160 row_newbcast:8 row_mask:0xf bank_mask:0xf
    v_dot2c_f32_bf16_dpp v49, v41, v160 row_newbcast:8 row_mask:0xf bank_mask:0xf
    v_dot2c_f32_bf16_dpp v50, v40, v161 row_newbcast:8 row_mask:0xf bank_mask:0xf
    v_dot2c_f32_bf16_dpp v51, v41, v161 row_newbcast:8 row_mask:0xf bank_mask:0xf
    v_dot2c_f32_bf16_dpp v52, v40, v162 row_newbcast:8 row_mask:0xf bank_mask:0xf
    v_dot2c_f32_bf16_dpp v53, v41, v162 row_newbcast:8 row_mask:0xf bank_mask:0xf
    v_dot2c_f32_bf16_dpp v54, v40, v163 row_newbcast:8 row_mask:0xf bank_mask:0xf
    v_dot2c_f32_bf16_dpp v55, v41, v163 row_newbcast:8 row_mask:0xf bank_mask:0xf
    v_dot2c_f32_bf16_dpp v48, v40, v164 row_newbcast:9 row_mask:0xf bank_mask:0xf
    v_dot2c_f32_bf16_dpp v49, v41, v164 row_newbcast:9 row_mask:0xf bank_mask:0xf
    v_dot2c_f32_bf16_dpp v50, v40, v165 row_newbcast:9 row_mask:0xf bank_mask:0xf
    v_dot2c_f32_bf16_dpp v51, v41, v165 row_newbcast:9 row_mask:0xf bank_mask:0xf
    v_dot2c_f32_bf16_dpp v52, v40, v166 row_newbcast:9 row_mask:0xf bank_mask:0xf
    v_dot2c_f32_bf16_dpp v53, v41, v166 row_newbcast:9 row_mask:0xf bank_mask:0xf
    v_dot2c_f32_bf16_dpp v54, v40, v167 row_newbcast:9 row_mask:0xf bank_mask:0xf
    v_dot2c_f32_bf16_dpp v55, v41, v167 row_newbcast:9 row_mask:0xf bank_mask:0xf
    v_dot2c_f32_bf16_dpp v48, v40, v168 row_newbcast:10 row_mask:0xf bank_mask:0xf
    v_dot2c_f32_bf16_dpp v49, v41, v168 row_newbcast:10 row_mask:0xf bank_mask:0xf
    v_dot2c_f32_bf16_dpp v50, v40, v169 row_newbcast:10 row_mask:0xf bank_mask:0xf
    v_dot2c_f32_bf16_dpp v51, v41, v169 row_newbcast:10 row_mask:0xf bank_mask:0xf
    v_dot2c_f32_bf16_dpp v52, v40, v170 row_newbcast:10 row_mask:0xf bank_mask:0xf
    v_dot2c_f32_bf16_dpp v53, v41, v170 row_newbcast:10 row_mask:0xf bank_mask:0xf
    v_dot2c_f32_bf16_dpp v54, v40, v171 row_newbcast:10 row_mask:0xf bank_mask:0xf
    v_dot2c_f32_bf16_dpp v55, v41, v171 row_newbcast:10 row_mask:0xf bank_mask:0xf
    v_dot2c_f32_bf16_dpp v48, v40, v172 row_newbcast:11 row_mask:0xf bank_mask:0xf
    v_dot2c_f32_bf16_dpp v49, v41, v172 row_newbcast:11 row_mask:0xf bank_mask:0xf
    v_dot2c_f32_bf16_dpp v50, v40, v173 row_newbcast:11 row_mask:0xf bank_mask:0xf
    v_dot2c_f32_bf16_dpp v51, v41, v173 row_newbcast:11 row_mask:0xf bank_mask:0xf
    v_dot2c_f32_bf16_dpp v52, v40, v174 row_newbcast:11 row_mask:0xf bank_mask:0xf
    v_dot2c_f32_bf16_dpp v53, v41, v174 row_newbcast:11 row_mask:0xf bank_mask:0xf
    v_dot2c_f32_bf16_dpp v54, v40, v175 row_newbcast:11 row_mask:0xf bank_mask:0xf
    v_dot2c_f32_bf16_dpp v55, v41, v175 row_newbcast:11 row_mask:0xf bank_mask:0xf
    v_dot2c_f32_bf16_dpp v48, v40, v176 row_newbcast:12 row_mask:0xf bank_mask:0xf
    v_dot2c_f32_bf16_dpp v49, v41, v176 row_newbcast:12 row_mask:0xf bank_mask:0xf
    v_dot2c_f32_bf16_dpp v50, v40, v177 row_newbcast:12 row_mask:0xf bank_mask:0xf
    v_dot2c_f32_bf16_dpp v51, v41, v177 row_newbcast:12 row_mask:0xf bank_mask:0xf
    v_dot2c_f32_bf16_dpp v52, v40, v178 row_newbcast:12 row_mask:0xf bank_mask:0xf
    v_dot2c_f32_bf16_dpp v53, v41, v178 row_newbcast:12 row_mask:0xf bank_mask:0xf
    v_dot2c_f32_bf16_dpp v54, v40, v179 row_newbcast:12 row_mask:0xf bank_mask:0xf
    v_dot2c_f32_bf16_dpp v55, v41, v179 row_newbcast:12 row_mask:0xf bank_mask:0xf
    v_dot2c_f32_bf16_dpp v48, v40, v180 row_newbcast:13 row_mask:0xf bank_mask:0xf
    v_dot2c_f32_bf16_dpp v49, v41, v180 row_newbcast:13 row_mask:0xf bank_mask:0xf
    v_dot2c_f32_bf16_dpp v50, v40, v181 row_newbcast:13 row_mask:0xf bank_mask:0xf
    v_dot2c_f32_bf16_dpp v51, v41, v181 row_newbcast:13 row_mask:0xf bank_mask:0xf
    v_dot2c_f32_bf16_dpp v52, v40, v182 row_newbcast:13 row_mask:0xf bank_mask:0xf
    v_dot2c_f32_bf16_dpp v53, v41, v182 row_newbcast:13 row_mask:0xf bank_mask:0xf
    v_dot2c_f32_bf16_dpp v54, v40, v183 row_newbcast:13 row_mask:0xf bank_mask:0xf
    v_dot2c_f32_bf16_dpp v55, v41, v183 row_newbcast:13 row_mask:0xf bank_mask:0xf
    v_dot2c_f32_bf16_dpp v48, v40, v184 row_newbcast:14 row_mask:0xf bank_mask:0xf
    v_dot2c_f32_bf16_dpp v49, v41, v184 row_newbcast:14 row_mask:0xf bank_mask:0xf
    v_dot2c_f32_bf16_dpp v50, v40, v185 row_newbcast:14 row_mask:0xf bank_mask:0xf
    v_dot2c_f32_bf16_dpp v51, v41, v185 row_newbcast:14 row_mask:0xf bank_mask:0xf
    v_dot2c_f32_bf16_dpp v52, v40, v186 row_newbcast:14 row_mask:0xf bank_mask:0xf
    v_dot2c_f32_bf16_dpp v53, v41, v186 row_newbcast:14 row_mask:0xf bank_mask:0xf
    v_dot2c_f32_bf16_dpp v54, v40, v187 row_newbcast:14 row_mask:0xf bank_mask:0xf
    v_dot2c_f32_bf16_dpp v55, v41, v187 row_newbcast:14 row_mask:0xf bank_mask:0xf
    v_dot2c_f32_bf16_dpp v48, v40, v188 row_newbcast:15 row_mask:0xf bank_mask:0xf
    v_dot2c_f32_bf16_dpp v49, v41, v188 row_newbcast:15 row_mask:0xf bank_mask:0xf
    v_dot2c_f32_bf16_dpp v50, v40, v189 row_newbcast:15 row_mask:0xf bank_mask:0xf
    v_dot2c_f32_bf16_dpp v51, v41, v189 row_newbcast:15 row_mask:0xf bank_mask:0xf
    v_dot2c_f32_bf16_dpp v52, v40, v190 row_newbcast:15 row_mask:0xf bank_mask:0xf
    v_dot2c_f32_bf16_dpp v53, v41, v190 row_newbcast:15 row_mask:0xf bank_mask:0xf
    v_dot2c_f32_bf16_dpp v54, v40, v191 row_newbcast:15 row_mask:0xf bank_mask:0xf
    v_dot2c_f32_bf16_dpp v55, v41, v191 row_newbcast:15 row_mask:0xf bank_mask:0xf
    s_mov_b32 s40, 0x60000
    buffer_load_dwordx4 v[128:131], v2, s[12:15], s40 offen offset:0 nt
    buffer_load_dwordx4 v[132:135], v2, s[12:15], s40 offen offset:1024 nt
    buffer_load_dwordx4 v[136:139], v2, s[12:15], s40 offen offset:2048 nt
    buffer_load_dwordx4 v[140:143], v2, s[12:15], s40 offen offset:3072 nt
    s_mov_b32 s40, 0x61000
    buffer_load_dwordx4 v[144:147], v2, s[12:15], s40 offen offset:0 nt
    buffer_load_dwordx4 v[148:151], v2, s[12:15], s40 offen offset:1024 nt
    buffer_load_dwordx4 v[152:155], v2, s[12:15], s40 offen offset:2048 nt
    buffer_load_dwordx4 v[156:159], v2, s[12:15], s40 offen offset:3072 nt
    s_mov_b32 s40, 0x62000
    buffer_load_dwordx4 v[160:163], v2, s[12:15], s40 offen offset:0 nt
    buffer_load_dwordx4 v[164:167], v2, s[12:15], s40 offen offset:1024 nt
    buffer_load_dwordx4 v[168:171], v2, s[12:15], s40 offen offset:2048 nt
    buffer_load_dwordx4 v[172:175], v2, s[12:15], s40 offen offset:3072 nt
    s_mov_b32 s40, 0x63000
    buffer_load_dwordx4 v[176:179], v2, s[12:15], s40 offen offset:0 nt
    buffer_load_dwordx4 v[180:183], v2, s[12:15], s40 offen offset:1024 nt
    buffer_load_dwordx4 v[184:187], v2, s[12:15], s40 offen offset:2048 nt
    buffer_load_dwordx4 v[188:191], v2, s[12:15], s40 offen offset:3072 nt
    s_waitcnt vmcnt(32)
    v_dot2c_f32_bf16_dpp v48, v42, v192 row_newbcast:0 row_mask:0xf bank_mask:0xf
    v_dot2c_f32_bf16_dpp v49, v43, v192 row_newbcast:0 row_mask:0xf bank_mask:0xf
    v_dot2c_f32_bf16_dpp v50, v42, v193 row_newbcast:0 row_mask:0xf bank_mask:0xf
    v_dot2c_f32_bf16_dpp v51, v43, v193 row_newbcast:0 row_mask:0xf bank_mask:0xf
    v_dot2c_f32_bf16_dpp v52, v42, v194 row_newbcast:0 row_mask:0xf bank_mask:0xf
    v_dot2c_f32_bf16_dpp v53, v43, v194 row_newbcast:0 row_mask:0xf bank_mask:0xf
    v_dot2c_f32_bf16_dpp v54, v42, v195 row_newbcast:0 row_mask:0xf bank_mask:0xf
    v_dot2c_f32_bf16_dpp v55, v43, v195 row_newbcast:0 row_mask:0xf bank_mask:0xf
    v_dot2c_f32_bf16_dpp v48, v42, v196 row_newbcast:1 row_mask:0xf bank_mask:0xf
    v_dot2c_f32_bf16_dpp v49, v43, v196 row_newbcast:1 row_mask:0xf bank_mask:0xf
    v_dot2c_f32_bf16_dpp v50, v42, v197 row_newbcast:1 row_mask:0xf bank_mask:0xf
    v_dot2c_f32_bf16_dpp v51, v43, v197 row_newbcast:1 row_mask:0xf bank_mask:0xf
    v_dot2c_f32_bf16_dpp v52, v42, v198 row_newbcast:1 row_mask:0xf bank_mask:0xf
    v_dot2c_f32_bf16_dpp v53, v43, v198 row_newbcast:1 row_mask:0xf bank_mask:0xf
    v_dot2c_f32_bf16_dpp v54, v42, v199 row_newbcast:1 row_mask:0xf bank_mask:0xf
    v_dot2c_f32_bf16_dpp v55, v43, v199 row_newbcast:1 row_mask:0xf bank_mask:0xf
    v_dot2c_f32_bf16_dpp v48, v42, v200 row_newbcast:2 row_mask:0xf bank_mask:0xf
    v_dot2c_f32_bf16_dpp v49, v43, v200 row_newbcast:2 row_mask:0xf bank_mask:0xf
    v_dot2c_f32_bf16_dpp v50, v42, v201 row_newbcast:2 row_mask:0xf bank_mask:0xf
    v_dot2c_f32_bf16_dpp v51, v43, v201 row_newbcast:2 row_mask:0xf bank_mask:0xf
    v_dot2c_f32_bf16_dpp v52, v42, v202 row_newbcast:2 row_mask:0xf bank_mask:0xf
    v_dot2c_f32_bf16_dpp v53, v43, v202 row_newbcast:2 row_mask:0xf bank_mask:0xf
    v_dot2c_f32_bf16_dpp v54, v42, v203 row_newbcast:2 row_mask:0xf bank_mask:0xf
    v_dot2c_f32_bf16_dpp v55, v43, v203 row_newbcast:2 row_mask:0xf bank_mask:0xf
    v_dot2c_f32_bf16_dpp v48, v42, v204 row_newbcast:3 row_mask:0xf bank_mask:0xf
    v_dot2c_f32_bf16_dpp v49, v43, v204 row_newbcast:3 row_mask:0xf bank_mask:0xf
    v_dot2c_f32_bf16_dpp v50, v42, v205 row_newbcast:3 row_mask:0xf bank_mask:0xf
    v_dot2c_f32_bf16_dpp v51, v43, v205 row_newbcast:3 row_mask:0xf bank_mask:0xf
    v_dot2c_f32_bf16_dpp v52, v42, v206 row_newbcast:3 row_mask:0xf bank_mask:0xf
    v_dot2c_f32_bf16_dpp v53, v43, v206 row_newbcast:3 row_mask:0xf bank_mask:0xf
    v_dot2c_f32_bf16_dpp v54, v42, v207 row_newbcast:3 row_mask:0xf bank_mask:0xf
    v_dot2c_f32_bf16_dpp v55, v43, v207 row_newbcast:3 row_mask:0xf bank_mask:0xf
    v_dot2c_f32_bf16_dpp v48, v42, v208 row_newbcast:4 row_mask:0xf bank_mask:0xf
    v_dot2c_f32_bf16_dpp v49, v43, v208 row_newbcast:4 row_mask:0xf bank_mask:0xf
    v_dot2c_f32_bf16_dpp v50, v42, v209 row_newbcast:4 row_mask:0xf bank_mask:0xf
    v_dot2c_f32_bf16_dpp v51, v43, v209 row_newbcast:4 row_mask:0xf bank_mask:0xf
    v_dot2c_f32_bf16_dpp v52, v42, v210 row_newbcast:4 row_mask:0xf bank_mask:0xf
    v_dot2c_f32_bf16_dpp v53, v43, v210 row_newbcast:4 row_mask:0xf bank_mask:0xf
    v_dot2c_f32_bf16_dpp v54, v42, v211 row_newbcast:4 row_mask:0xf bank_mask:0xf
    v_dot2c_f32_bf16_dpp v55, v43, v211 row_newbcast:4 row_mask:0xf bank_mask:0xf
    v_dot2c_f32_bf16_dpp v48, v42, v212 row_newbcast:5 row_mask:0xf bank_mask:0xf
    v_dot2c_f32_bf16_dpp v49, v43, v212 row_newbcast:5 row_mask:0xf bank_mask:0xf
    v_dot2c_f32_bf16_dpp v50, v42, v213 row_newbcast:5 row_mask:0xf bank_mask:0xf
    v_dot2c_f32_bf16_dpp v51, v43, v213 row_newbcast:5 row_mask:0xf bank_mask:0xf
    v_dot2c_f32_bf16_dpp v52, v42, v214 row_newbcast:5 row_mask:0xf bank_mask:0xf
    v_dot2c_f32_bf16_dpp v53, v43, v214 row_newbcast:5 row_mask:0xf bank_mask:0xf
    v_dot2c_f32_bf16_dpp v54, v42, v215 row_newbcast:5 row_mask:0xf bank_mask:0xf
    v_dot2c_f32_bf16_dpp v55, v43, v215 row_newbcast:5 row_mask:0xf bank_mask:0xf
    v_dot2c_f32_bf16_dpp v48, v42, v216 row_newbcast:6 row_mask:0xf bank_mask:0xf
    v_dot2c_f32_bf16_dpp v49, v43, v216 row_newbcast:6 row_mask:0xf bank_mask:0xf
    v_dot2c_f32_bf16_dpp v50, v42, v217 row_newbcast:6 row_mask:0xf bank_mask:0xf
    v_dot2c_f32_bf16_dpp v51, v43, v217 row_newbcast:6 row_mask:0xf bank_mask:0xf
    v_dot2c_f32_bf16_dpp v52, v42, v218 row_newbcast:6 row_mask:0xf bank_mask:0xf
    v_dot2c_f32_bf16_dpp v53, v43, v218 row_newbcast:6 row_mask:0xf bank_mask:0xf
    v_dot2c_f32_bf16_dpp v54, v42, v219 row_newbcast:6 row_mask:0xf bank_mask:0xf
    v_dot2c_f32_bf16_dpp v55, v43, v219 row_newbcast:6 row_mask:0xf bank_mask:0xf
    v_dot2c_f32_bf16_dpp v48, v42, v220 row_newbcast:7 row_mask:0xf bank_mask:0xf
    v_dot2c_f32_bf16_dpp v49, v43, v220 row_newbcast:7 row_mask:0xf bank_mask:0xf
    v_dot2c_f32_bf16_dpp v50, v42, v221 row_newbcast:7 row_mask:0xf bank_mask:0xf
    v_dot2c_f32_bf16_dpp v51, v43, v221 row_newbcast:7 row_mask:0xf bank_mask:0xf
    v_dot2c_f32_bf16_dpp v52, v42, v222 row_newbcast:7 row_mask:0xf bank_mask:0xf
    v_dot2c_f32_bf16_dpp v53, v43, v222 row_newbcast:7 row_mask:0xf bank_mask:0xf
    v_dot2c_f32_bf16_dpp v54, v42, v223 row_newbcast:7 row_mask:0xf bank_mask:0xf
    v_dot2c_f32_bf16_dpp v55, v43, v223 row_newbcast:7 row_mask:0xf bank_mask:0xf
    v_dot2c_f32_bf16_dpp v48, v42, v224 row_newbcast:8 row_mask:0xf bank_mask:0xf
    v_dot2c_f32_bf16_dpp v49, v43, v224 row_newbcast:8 row_mask:0xf bank_mask:0xf
    v_dot2c_f32_bf16_dpp v50, v42, v225 row_newbcast:8 row_mask:0xf bank_mask:0xf
    v_dot2c_f32_bf16_dpp v51, v43, v225 row_newbcast:8 row_mask:0xf bank_mask:0xf
    v_dot2c_f32_bf16_dpp v52, v42, v226 row_newbcast:8 row_mask:0xf bank_mask:0xf
    v_dot2c_f32_bf16_dpp v53, v43, v226 row_newbcast:8 row_mask:0xf bank_mask:0xf
    v_dot2c_f32_bf16_dpp v54, v42, v227 row_newbcast:8 row_mask:0xf bank_mask:0xf
    v_dot2c_f32_bf16_dpp v55, v43, v227 row_newbcast:8 row_mask:0xf bank_mask:0xf
    v_dot2c_f32_bf16_dpp v48, v42, v228 row_newbcast:9 row_mask:0xf bank_mask:0xf
    v_dot2c_f32_bf16_dpp v49, v43, v228 row_newbcast:9 row_mask:0xf bank_mask:0xf
    v_dot2c_f32_bf16_dpp v50, v42, v229 row_newbcast:9 row_mask:0xf bank_mask:0xf
    v_dot2c_f32_bf16_dpp v51, v43, v229 row_newbcast:9 row_mask:0xf bank_mask:0xf
    v_dot2c_f32_bf16_dpp v52, v42, v230 row_newbcast:9 row_mask:0xf bank_mask:0xf
    v_dot2c_f32_bf16_dpp v53, v43, v230 row_newbcast:9 row_mask:0xf bank_mask:0xf
    v_dot2c_f32_bf16_dpp v54, v42, v231 row_newbcast:9 row_mask:0xf bank_mask:0xf
    v_dot2c_f32_bf16_dpp v55, v43, v231 row_newbcast:9 row_mask:0xf bank_mask:0xf
    v_dot2c_f32_bf16_dpp v48, v42, v232 row_newbcast:10 row_mask:0xf bank_mask:0xf
    v_dot2c_f32_bf16_dpp v49, v43, v232 row_newbcast:10 row_mask:0xf bank_mask:0xf
    v_dot2c_f32_bf16_dpp v50, v42, v233 row_newbcast:10 row_mask:0xf bank_mask:0xf
    v_dot2c_f32_bf16_dpp v51, v43, v233 row_newbcast:10 row_mask:0xf bank_mask:0xf
    v_dot2c_f32_bf16_dpp v52, v42, v234 row_newbcast:10 row_mask:0xf bank_mask:0xf
    v_dot2c_f32_bf16_dpp v53, v43, v234 row_newbcast:10 row_mask:0xf bank_mask:0xf
    v_dot2c_f32_bf16_dpp v54, v42, v235 row_newbcast:10 row_mask:0xf bank_mask:0xf
    v_dot2c_f32_bf16_dpp v55, v43, v235 row_newbcast:10 row_mask:0xf bank_mask:0xf
    v_dot2c_f32_bf16_dpp v48, v42, v236 row_newbcast:11 row_mask:0xf bank_mask:0xf
    v_dot2c_f32_bf16_dpp v49, v43, v236 row_newbcast:11 row_mask:0xf bank_mask:0xf
    v_dot2c_f32_bf16_dpp v50, v42, v237 row_newbcast:11 row_mask:0xf bank_mask:0xf
    v_dot2c_f32_bf16_dpp v51, v43, v237 row_newbcast:11 row_mask:0xf bank_mask:0xf
    v_dot2c_f32_bf16_dpp v52, v42, v238 row_newbcast:11 row_mask:0xf bank_mask:0xf
    v_dot2c_f32_bf16_dpp v53, v43, v238 row_newbcast:11 row_mask:0xf bank_mask:0xf
    v_dot2c_f32_bf16_dpp v54, v42, v239 row_newbcast:11 row_mask:0xf bank_mask:0xf
    v_dot2c_f32_bf16_dpp v55, v43, v239 row_newbcast:11 row_mask:0xf bank_mask:0xf
    v_dot2c_f32_bf16_dpp v48, v42, v240 row_newbcast:12 row_mask:0xf bank_mask:0xf
    v_dot2c_f32_bf16_dpp v49, v43, v240 row_newbcast:12 row_mask:0xf bank_mask:0xf
    v_dot2c_f32_bf16_dpp v50, v42, v241 row_newbcast:12 row_mask:0xf bank_mask:0xf
    v_dot2c_f32_bf16_dpp v51, v43, v241 row_newbcast:12 row_mask:0xf bank_mask:0xf
    v_dot2c_f32_bf16_dpp v52, v42, v242 row_newbcast:12 row_mask:0xf bank_mask:0xf
    v_dot2c_f32_bf16_dpp v53, v43, v242 row_newbcast:12 row_mask:0xf bank_mask:0xf
    v_dot2c_f32_bf16_dpp v54, v42, v243 row_newbcast:12 row_mask:0xf bank_mask:0xf
    v_dot2c_f32_bf16_dpp v55, v43, v243 row_newbcast:12 row_mask:0xf bank_mask:0xf
    v_dot2c_f32_bf16_dpp v48, v42, v244 row_newbcast:13 row_mask:0xf bank_mask:0xf
    v_dot2c_f32_bf16_dpp v49, v43, v244 row_newbcast:13 row_mask:0xf bank_mask:0xf
    v_dot2c_f32_bf16_dpp v50, v42, v245 row_newbcast:13 row_mask:0xf bank_mask:0xf
    v_dot2c_f32_bf16_dpp v51, v43, v245 row_newbcast:13 row_mask:0xf bank_mask:0xf
    v_dot2c_f32_bf16_dpp v52, v42, v246 row_newbcast:13 row_mask:0xf bank_mask:0xf
    v_dot2c_f32_bf16_dpp v53, v43, v246 row_newbcast:13 row_mask:0xf bank_mask:0xf
    v_dot2c_f32_bf16_dpp v54, v42, v247 row_newbcast:13 row_mask:0xf bank_mask:0xf
    v_dot2c_f32_bf16_dpp v55, v43, v247 row_newbcast:13 row_mask:0xf bank_mask:0xf
    v_dot2c_f32_bf16_dpp v48, v42, v248 row_newbcast:14 row_mask:0xf bank_mask:0xf
    v_dot2c_f32_bf16_dpp v49, v43, v248 row_newbcast:14 row_mask:0xf bank_mask:0xf
    v_dot2c_f32_bf16_dpp v50, v42, v249 row_newbcast:14 row_mask:0xf bank_mask:0xf
    v_dot2c_f32_bf16_dpp v51, v43, v249 row_newbcast:14 row_mask:0xf bank_mask:0xf
    v_dot2c_f32_bf16_dpp v52, v42, v250 row_newbcast:14 row_mask:0xf bank_mask:0xf
    v_dot2c_f32_bf16_dpp v53, v43, v250 row_newbcast:14 row_mask:0xf bank_mask:0xf
    v_dot2c_f32_bf16_dpp v54, v42, v251 row_newbcast:14 row_mask:0xf bank_mask:0xf
    v_dot2c_f32_bf16_dpp v55, v43, v251 row_newbcast:14 row_mask:0xf bank_mask:0xf
    v_dot2c_f32_bf16_dpp v48, v42, v252 row_newbcast:15 row_mask:0xf bank_mask:0xf
    v_dot2c_f32_bf16_dpp v49, v43, v252 row_newbcast:15 row_mask:0xf bank_mask:0xf
    v_dot2c_f32_bf16_dpp v50, v42, v253 row_newbcast:15 row_mask:0xf bank_mask:0xf
    v_dot2c_f32_bf16_dpp v51, v43, v253 row_newbcast:15 row_mask:0xf bank_mask:0xf
    v_dot2c_f32_bf16_dpp v52, v42, v254 row_newbcast:15 row_mask:0xf bank_mask:0xf
    v_dot2c_f32_bf16_dpp v53, v43, v254 row_newbcast:15 row_mask:0xf bank_mask:0xf
    v_dot2c_f32_bf16_dpp v54, v42, v255 row_newbcast:15 row_mask:0xf bank_mask:0xf
    v_dot2c_f32_bf16_dpp v55, v43, v255 row_newbcast:15 row_mask:0xf bank_mask:0xf
    s_waitcnt vmcnt(16)
    v_dot2c_f32_bf16_dpp v48, v44, v64 row_newbcast:0 row_mask:0xf bank_mask:0xf
    v_dot2c_f32_bf16_dpp v49, v45, v64 row_newbcast:0 row_mask:0xf bank_mask:0xf
    v_dot2c_f32_bf16_dpp v50, v44, v65 row_newbcast:0 row_mask:0xf bank_mask:0xf
    v_dot2c_f32_bf16_dpp v51, v45, v65 row_newbcast:0 row_mask:0xf bank_mask:0xf
    v_dot2c_f32_bf16_dpp v52, v44, v66 row_newbcast:0 row_mask:0xf bank_mask:0xf
    v_dot2c_f32_bf16_dpp v53, v45, v66 row_newbcast:0 row_mask:0xf bank_mask:0xf
    v_dot2c_f32_bf16_dpp v54, v44, v67 row_newbcast:0 row_mask:0xf bank_mask:0xf
    v_dot2c_f32_bf16_dpp v55, v45, v67 row_newbcast:0 row_mask:0xf bank_mask:0xf
    v_dot2c_f32_bf16_dpp v48, v44, v68 row_newbcast:1 row_mask:0xf bank_mask:0xf
    v_dot2c_f32_bf16_dpp v49, v45, v68 row_newbcast:1 row_mask:0xf bank_mask:0xf
    v_dot2c_f32_bf16_dpp v50, v44, v69 row_newbcast:1 row_mask:0xf bank_mask:0xf
    v_dot2c_f32_bf16_dpp v51, v45, v69 row_newbcast:1 row_mask:0xf bank_mask:0xf
    v_dot2c_f32_bf16_dpp v52, v44, v70 row_newbcast:1 row_mask:0xf bank_mask:0xf
    v_dot2c_f32_bf16_dpp v53, v45, v70 row_newbcast:1 row_mask:0xf bank_mask:0xf
    v_dot2c_f32_bf16_dpp v54, v44, v71 row_newbcast:1 row_mask:0xf bank_mask:0xf
    v_dot2c_f32_bf16_dpp v55, v45, v71 row_newbcast:1 row_mask:0xf bank_mask:0xf
    v_dot2c_f32_bf16_dpp v48, v44, v72 row_newbcast:2 row_mask:0xf bank_mask:0xf
    v_dot2c_f32_bf16_dpp v49, v45, v72 row_newbcast:2 row_mask:0xf bank_mask:0xf
    v_dot2c_f32_bf16_dpp v50, v44, v73 row_newbcast:2 row_mask:0xf bank_mask:0xf
    v_dot2c_f32_bf16_dpp v51, v45, v73 row_newbcast:2 row_mask:0xf bank_mask:0xf
    v_dot2c_f32_bf16_dpp v52, v44, v74 row_newbcast:2 row_mask:0xf bank_mask:0xf
    v_dot2c_f32_bf16_dpp v53, v45, v74 row_newbcast:2 row_mask:0xf bank_mask:0xf
    v_dot2c_f32_bf16_dpp v54, v44, v75 row_newbcast:2 row_mask:0xf bank_mask:0xf
    v_dot2c_f32_bf16_dpp v55, v45, v75 row_newbcast:2 row_mask:0xf bank_mask:0xf
    v_dot2c_f32_bf16_dpp v48, v44, v76 row_newbcast:3 row_mask:0xf bank_mask:0xf
    v_dot2c_f32_bf16_dpp v49, v45, v76 row_newbcast:3 row_mask:0xf bank_mask:0xf
    v_dot2c_f32_bf16_dpp v50, v44, v77 row_newbcast:3 row_mask:0xf bank_mask:0xf
    v_dot2c_f32_bf16_dpp v51, v45, v77 row_newbcast:3 row_mask:0xf bank_mask:0xf
    v_dot2c_f32_bf16_dpp v52, v44, v78 row_newbcast:3 row_mask:0xf bank_mask:0xf
    v_dot2c_f32_bf16_dpp v53, v45, v78 row_newbcast:3 row_mask:0xf bank_mask:0xf
    v_dot2c_f32_bf16_dpp v54, v44, v79 row_newbcast:3 row_mask:0xf bank_mask:0xf
    v_dot2c_f32_bf16_dpp v55, v45, v79 row_newbcast:3 row_mask:0xf bank_mask:0xf
    v_dot2c_f32_bf16_dpp v48, v44, v80 row_newbcast:4 row_mask:0xf bank_mask:0xf
    v_dot2c_f32_bf16_dpp v49, v45, v80 row_newbcast:4 row_mask:0xf bank_mask:0xf
    v_dot2c_f32_bf16_dpp v50, v44, v81 row_newbcast:4 row_mask:0xf bank_mask:0xf
    v_dot2c_f32_bf16_dpp v51, v45, v81 row_newbcast:4 row_mask:0xf bank_mask:0xf
    v_dot2c_f32_bf16_dpp v52, v44, v82 row_newbcast:4 row_mask:0xf bank_mask:0xf
    v_dot2c_f32_bf16_dpp v53, v45, v82 row_newbcast:4 row_mask:0xf bank_mask:0xf
    v_dot2c_f32_bf16_dpp v54, v44, v83 row_newbcast:4 row_mask:0xf bank_mask:0xf
    v_dot2c_f32_bf16_dpp v55, v45, v83 row_newbcast:4 row_mask:0xf bank_mask:0xf
    v_dot2c_f32_bf16_dpp v48, v44, v84 row_newbcast:5 row_mask:0xf bank_mask:0xf
    v_dot2c_f32_bf16_dpp v49, v45, v84 row_newbcast:5 row_mask:0xf bank_mask:0xf
    v_dot2c_f32_bf16_dpp v50, v44, v85 row_newbcast:5 row_mask:0xf bank_mask:0xf
    v_dot2c_f32_bf16_dpp v51, v45, v85 row_newbcast:5 row_mask:0xf bank_mask:0xf
    v_dot2c_f32_bf16_dpp v52, v44, v86 row_newbcast:5 row_mask:0xf bank_mask:0xf
    v_dot2c_f32_bf16_dpp v53, v45, v86 row_newbcast:5 row_mask:0xf bank_mask:0xf
    v_dot2c_f32_bf16_dpp v54, v44, v87 row_newbcast:5 row_mask:0xf bank_mask:0xf
    v_dot2c_f32_bf16_dpp v55, v45, v87 row_newbcast:5 row_mask:0xf bank_mask:0xf
    v_dot2c_f32_bf16_dpp v48, v44, v88 row_newbcast:6 row_mask:0xf bank_mask:0xf
    v_dot2c_f32_bf16_dpp v49, v45, v88 row_newbcast:6 row_mask:0xf bank_mask:0xf
    v_dot2c_f32_bf16_dpp v50, v44, v89 row_newbcast:6 row_mask:0xf bank_mask:0xf
    v_dot2c_f32_bf16_dpp v51, v45, v89 row_newbcast:6 row_mask:0xf bank_mask:0xf
    v_dot2c_f32_bf16_dpp v52, v44, v90 row_newbcast:6 row_mask:0xf bank_mask:0xf
    v_dot2c_f32_bf16_dpp v53, v45, v90 row_newbcast:6 row_mask:0xf bank_mask:0xf
    v_dot2c_f32_bf16_dpp v54, v44, v91 row_newbcast:6 row_mask:0xf bank_mask:0xf
    v_dot2c_f32_bf16_dpp v55, v45, v91 row_newbcast:6 row_mask:0xf bank_mask:0xf
    v_dot2c_f32_bf16_dpp v48, v44, v92 row_newbcast:7 row_mask:0xf bank_mask:0xf
    v_dot2c_f32_bf16_dpp v49, v45, v92 row_newbcast:7 row_mask:0xf bank_mask:0xf
    v_dot2c_f32_bf16_dpp v50, v44, v93 row_newbcast:7 row_mask:0xf bank_mask:0xf
    v_dot2c_f32_bf16_dpp v51, v45, v93 row_newbcast:7 row_mask:0xf bank_mask:0xf
    v_dot2c_f32_bf16_dpp v52, v44, v94 row_newbcast:7 row_mask:0xf bank_mask:0xf
    v_dot2c_f32_bf16_dpp v53, v45, v94 row_newbcast:7 row_mask:0xf bank_mask:0xf
    v_dot2c_f32_bf16_dpp v54, v44, v95 row_newbcast:7 row_mask:0xf bank_mask:0xf
    v_dot2c_f32_bf16_dpp v55, v45, v95 row_newbcast:7 row_mask:0xf bank_mask:0xf
    v_dot2c_f32_bf16_dpp v48, v44, v96 row_newbcast:8 row_mask:0xf bank_mask:0xf
    v_dot2c_f32_bf16_dpp v49, v45, v96 row_newbcast:8 row_mask:0xf bank_mask:0xf
    v_dot2c_f32_bf16_dpp v50, v44, v97 row_newbcast:8 row_mask:0xf bank_mask:0xf
    v_dot2c_f32_bf16_dpp v51, v45, v97 row_newbcast:8 row_mask:0xf bank_mask:0xf
    v_dot2c_f32_bf16_dpp v52, v44, v98 row_newbcast:8 row_mask:0xf bank_mask:0xf
    v_dot2c_f32_bf16_dpp v53, v45, v98 row_newbcast:8 row_mask:0xf bank_mask:0xf
    v_dot2c_f32_bf16_dpp v54, v44, v99 row_newbcast:8 row_mask:0xf bank_mask:0xf
    v_dot2c_f32_bf16_dpp v55, v45, v99 row_newbcast:8 row_mask:0xf bank_mask:0xf
    v_dot2c_f32_bf16_dpp v48, v44, v100 row_newbcast:9 row_mask:0xf bank_mask:0xf
    v_dot2c_f32_bf16_dpp v49, v45, v100 row_newbcast:9 row_mask:0xf bank_mask:0xf
    v_dot2c_f32_bf16_dpp v50, v44, v101 row_newbcast:9 row_mask:0xf bank_mask:0xf
    v_dot2c_f32_bf16_dpp v51, v45, v101 row_newbcast:9 row_mask:0xf bank_mask:0xf
    v_dot2c_f32_bf16_dpp v52, v44, v102 row_newbcast:9 row_mask:0xf bank_mask:0xf
    v_dot2c_f32_bf16_dpp v53, v45, v102 row_newbcast:9 row_mask:0xf bank_mask:0xf
    v_dot2c_f32_bf16_dpp v54, v44, v103 row_newbcast:9 row_mask:0xf bank_mask:0xf
    v_dot2c_f32_bf16_dpp v55, v45, v103 row_newbcast:9 row_mask:0xf bank_mask:0xf
    v_dot2c_f32_bf16_dpp v48, v44, v104 row_newbcast:10 row_mask:0xf bank_mask:0xf
    v_dot2c_f32_bf16_dpp v49, v45, v104 row_newbcast:10 row_mask:0xf bank_mask:0xf
    v_dot2c_f32_bf16_dpp v50, v44, v105 row_newbcast:10 row_mask:0xf bank_mask:0xf
    v_dot2c_f32_bf16_dpp v51, v45, v105 row_newbcast:10 row_mask:0xf bank_mask:0xf
    v_dot2c_f32_bf16_dpp v52, v44, v106 row_newbcast:10 row_mask:0xf bank_mask:0xf
    v_dot2c_f32_bf16_dpp v53, v45, v106 row_newbcast:10 row_mask:0xf bank_mask:0xf
    v_dot2c_f32_bf16_dpp v54, v44, v107 row_newbcast:10 row_mask:0xf bank_mask:0xf
    v_dot2c_f32_bf16_dpp v55, v45, v107 row_newbcast:10 row_mask:0xf bank_mask:0xf
    v_dot2c_f32_bf16_dpp v48, v44, v108 row_newbcast:11 row_mask:0xf bank_mask:0xf
    v_dot2c_f32_bf16_dpp v49, v45, v108 row_newbcast:11 row_mask:0xf bank_mask:0xf
    v_dot2c_f32_bf16_dpp v50, v44, v109 row_newbcast:11 row_mask:0xf bank_mask:0xf
    v_dot2c_f32_bf16_dpp v51, v45, v109 row_newbcast:11 row_mask:0xf bank_mask:0xf
    v_dot2c_f32_bf16_dpp v52, v44, v110 row_newbcast:11 row_mask:0xf bank_mask:0xf
    v_dot2c_f32_bf16_dpp v53, v45, v110 row_newbcast:11 row_mask:0xf bank_mask:0xf
    v_dot2c_f32_bf16_dpp v54, v44, v111 row_newbcast:11 row_mask:0xf bank_mask:0xf
    v_dot2c_f32_bf16_dpp v55, v45, v111 row_newbcast:11 row_mask:0xf bank_mask:0xf
    v_dot2c_f32_bf16_dpp v48, v44, v112 row_newbcast:12 row_mask:0xf bank_mask:0xf
    v_dot2c_f32_bf16_dpp v49, v45, v112 row_newbcast:12 row_mask:0xf bank_mask:0xf
    v_dot2c_f32_bf16_dpp v50, v44, v113 row_newbcast:12 row_mask:0xf bank_mask:0xf
    v_dot2c_f32_bf16_dpp v51, v45, v113 row_newbcast:12 row_mask:0xf bank_mask:0xf
    v_dot2c_f32_bf16_dpp v52, v44, v114 row_newbcast:12 row_mask:0xf bank_mask:0xf
    v_dot2c_f32_bf16_dpp v53, v45, v114 row_newbcast:12 row_mask:0xf bank_mask:0xf
    v_dot2c_f32_bf16_dpp v54, v44, v115 row_newbcast:12 row_mask:0xf bank_mask:0xf
    v_dot2c_f32_bf16_dpp v55, v45, v115 row_newbcast:12 row_mask:0xf bank_mask:0xf
    v_dot2c_f32_bf16_dpp v48, v44, v116 row_newbcast:13 row_mask:0xf bank_mask:0xf
    v_dot2c_f32_bf16_dpp v49, v45, v116 row_newbcast:13 row_mask:0xf bank_mask:0xf
    v_dot2c_f32_bf16_dpp v50, v44, v117 row_newbcast:13 row_mask:0xf bank_mask:0xf
    v_dot2c_f32_bf16_dpp v51, v45, v117 row_newbcast:13 row_mask:0xf bank_mask:0xf
    v_dot2c_f32_bf16_dpp v52, v44, v118 row_newbcast:13 row_mask:0xf bank_mask:0xf
    v_dot2c_f32_bf16_dpp v53, v45, v118 row_newbcast:13 row_mask:0xf bank_mask:0xf
    v_dot2c_f32_bf16_dpp v54, v44, v119 row_newbcast:13 row_mask:0xf bank_mask:0xf
    v_dot2c_f32_bf16_dpp v55, v45, v119 row_newbcast:13 row_mask:0xf bank_mask:0xf
    v_dot2c_f32_bf16_dpp v48, v44, v120 row_newbcast:14 row_mask:0xf bank_mask:0xf
    v_dot2c_f32_bf16_dpp v49, v45, v120 row_newbcast:14 row_mask:0xf bank_mask:0xf
    v_dot2c_f32_bf16_dpp v50, v44, v121 row_newbcast:14 row_mask:0xf bank_mask:0xf
    v_dot2c_f32_bf16_dpp v51, v45, v121 row_newbcast:14 row_mask:0xf bank_mask:0xf
    v_dot2c_f32_bf16_dpp v52, v44, v122 row_newbcast:14 row_mask:0xf bank_mask:0xf
    v_dot2c_f32_bf16_dpp v53, v45, v122 row_newbcast:14 row_mask:0xf bank_mask:0xf
    v_dot2c_f32_bf16_dpp v54, v44, v123 row_newbcast:14 row_mask:0xf bank_mask:0xf
    v_dot2c_f32_bf16_dpp v55, v45, v123 row_newbcast:14 row_mask:0xf bank_mask:0xf
    v_dot2c_f32_bf16_dpp v48, v44, v124 row_newbcast:15 row_mask:0xf bank_mask:0xf
    v_dot2c_f32_bf16_dpp v49, v45, v124 row_newbcast:15 row_mask:0xf bank_mask:0xf
    v_dot2c_f32_bf16_dpp v50, v44, v125 row_newbcast:15 row_mask:0xf bank_mask:0xf
    v_dot2c_f32_bf16_dpp v51, v45, v125 row_newbcast:15 row_mask:0xf bank_mask:0xf
    v_dot2c_f32_bf16_dpp v52, v44, v126 row_newbcast:15 row_mask:0xf bank_mask:0xf
    v_dot2c_f32_bf16_dpp v53, v45, v126 row_newbcast:15 row_mask:0xf bank_mask:0xf
    v_dot2c_f32_bf16_dpp v54, v44, v127 row_newbcast:15 row_mask:0xf bank_mask:0xf
    v_dot2c_f32_bf16_dpp v55, v45, v127 row_newbcast:15 row_mask:0xf bank_mask:0xf
    s_and_b32 s37, s2, 7
    s_lshr_b32 s38, s2, 3
    s_lshl_b32 s39, s37, 19
    s_lshl_b32 s40, s38, 14
    s_add_u32 s39, s39, s40
    v_lshlrev_b32 v60, 6, v0
    v_add_u32 v60, s39, v60
    s_cmp_ge_u32 s36, 4
    s_cbranch_scc1 L_pref_gu
    buffer_load_dword v61, v60, s[52:55], 0 offen
    s_branch L_pref_done
L_pref_gu:
    s_nop 4
    v_subrev_u32 v60, 256, v0
    v_lshrrev_b32 v61, 4, v60
    s_lshl_b32 s39, s38, 4
    v_add_u32 v61, s39, v61
    v_mul_u32_u24 v61, 3584, v61
    v_and_b32 v62, 7, v60
    v_lshlrev_b32 v62, 6, v62
    v_add_u32 v61, v61, v62
    s_mul_i32 s39, s37, 448
    s_and_b32 s39, s39, 0xffffff80
    v_add_u32 v61, s39, v61
    buffer_load_dword v62, v61, s[56:59], 0 offen
    buffer_load_dword v63, v61, s[60:63], 0 offen
    s_mul_i32 s39, s38, 56
    v_add_u32 v61, s39, v60
    v_lshlrev_b32 v61, 10, v61
    s_lshl_b32 s39, s37, 7
    v_add_u32 v61, s39, v61
    v_cmp_gt_u32 vcc, 56, v60
    s_nop 0
    s_and_saveexec_b64 s[42:43], vcc
    s_cbranch_execz L_pref_dskip
    buffer_load_dword v62, v61, s[64:67], 0 offen
    buffer_load_dword v63, v61, s[64:67], 0 offen offset:64
L_pref_dskip:
    s_nop 4
    s_or_b64 exec, exec, s[42:43]
L_pref_done:
    s_nop 4
    s_cmp_lg_u32 s36, 3
    s_cbranch_scc1 L_cpref_done
    s_getpc_b64 s[76:77]
L_cpref_pc:
    s_add_u32 s76, s76, wo_kernel-L_cpref_pc
    s_addc_u32 s77, s77, 0
    s_mov_b32 s78, 8192
    s_mov_b32 s79, 0x00020000
    v_lshlrev_b32 v60, 6, v1
    buffer_load_dword v61, v60, s[76:79], 0 offen
    buffer_load_dword v62, v60, s[76:79], 0 offen offset:4032
L_cpref_done:
    s_nop 4
    s_waitcnt vmcnt(0)
    v_dot2c_f32_bf16_dpp v48, v46, v128 row_newbcast:0 row_mask:0xf bank_mask:0xf
    v_dot2c_f32_bf16_dpp v49, v47, v128 row_newbcast:0 row_mask:0xf bank_mask:0xf
    v_dot2c_f32_bf16_dpp v50, v46, v129 row_newbcast:0 row_mask:0xf bank_mask:0xf
    v_dot2c_f32_bf16_dpp v51, v47, v129 row_newbcast:0 row_mask:0xf bank_mask:0xf
    v_dot2c_f32_bf16_dpp v52, v46, v130 row_newbcast:0 row_mask:0xf bank_mask:0xf
    v_dot2c_f32_bf16_dpp v53, v47, v130 row_newbcast:0 row_mask:0xf bank_mask:0xf
    v_dot2c_f32_bf16_dpp v54, v46, v131 row_newbcast:0 row_mask:0xf bank_mask:0xf
    v_dot2c_f32_bf16_dpp v55, v47, v131 row_newbcast:0 row_mask:0xf bank_mask:0xf
    v_dot2c_f32_bf16_dpp v48, v46, v132 row_newbcast:1 row_mask:0xf bank_mask:0xf
    v_dot2c_f32_bf16_dpp v49, v47, v132 row_newbcast:1 row_mask:0xf bank_mask:0xf
    v_dot2c_f32_bf16_dpp v50, v46, v133 row_newbcast:1 row_mask:0xf bank_mask:0xf
    v_dot2c_f32_bf16_dpp v51, v47, v133 row_newbcast:1 row_mask:0xf bank_mask:0xf
    v_dot2c_f32_bf16_dpp v52, v46, v134 row_newbcast:1 row_mask:0xf bank_mask:0xf
    v_dot2c_f32_bf16_dpp v53, v47, v134 row_newbcast:1 row_mask:0xf bank_mask:0xf
    v_dot2c_f32_bf16_dpp v54, v46, v135 row_newbcast:1 row_mask:0xf bank_mask:0xf
    v_dot2c_f32_bf16_dpp v55, v47, v135 row_newbcast:1 row_mask:0xf bank_mask:0xf
    v_dot2c_f32_bf16_dpp v48, v46, v136 row_newbcast:2 row_mask:0xf bank_mask:0xf
    v_dot2c_f32_bf16_dpp v49, v47, v136 row_newbcast:2 row_mask:0xf bank_mask:0xf
    v_dot2c_f32_bf16_dpp v50, v46, v137 row_newbcast:2 row_mask:0xf bank_mask:0xf
    v_dot2c_f32_bf16_dpp v51, v47, v137 row_newbcast:2 row_mask:0xf bank_mask:0xf
    v_dot2c_f32_bf16_dpp v52, v46, v138 row_newbcast:2 row_mask:0xf bank_mask:0xf
    v_dot2c_f32_bf16_dpp v53, v47, v138 row_newbcast:2 row_mask:0xf bank_mask:0xf
    v_dot2c_f32_bf16_dpp v54, v46, v139 row_newbcast:2 row_mask:0xf bank_mask:0xf
    v_dot2c_f32_bf16_dpp v55, v47, v139 row_newbcast:2 row_mask:0xf bank_mask:0xf
    v_dot2c_f32_bf16_dpp v48, v46, v140 row_newbcast:3 row_mask:0xf bank_mask:0xf
    v_dot2c_f32_bf16_dpp v49, v47, v140 row_newbcast:3 row_mask:0xf bank_mask:0xf
    v_dot2c_f32_bf16_dpp v50, v46, v141 row_newbcast:3 row_mask:0xf bank_mask:0xf
    v_dot2c_f32_bf16_dpp v51, v47, v141 row_newbcast:3 row_mask:0xf bank_mask:0xf
    v_dot2c_f32_bf16_dpp v52, v46, v142 row_newbcast:3 row_mask:0xf bank_mask:0xf
    v_dot2c_f32_bf16_dpp v53, v47, v142 row_newbcast:3 row_mask:0xf bank_mask:0xf
    v_dot2c_f32_bf16_dpp v54, v46, v143 row_newbcast:3 row_mask:0xf bank_mask:0xf
    v_dot2c_f32_bf16_dpp v55, v47, v143 row_newbcast:3 row_mask:0xf bank_mask:0xf
    v_dot2c_f32_bf16_dpp v48, v46, v144 row_newbcast:4 row_mask:0xf bank_mask:0xf
    v_dot2c_f32_bf16_dpp v49, v47, v144 row_newbcast:4 row_mask:0xf bank_mask:0xf
    v_dot2c_f32_bf16_dpp v50, v46, v145 row_newbcast:4 row_mask:0xf bank_mask:0xf
    v_dot2c_f32_bf16_dpp v51, v47, v145 row_newbcast:4 row_mask:0xf bank_mask:0xf
    v_dot2c_f32_bf16_dpp v52, v46, v146 row_newbcast:4 row_mask:0xf bank_mask:0xf
    v_dot2c_f32_bf16_dpp v53, v47, v146 row_newbcast:4 row_mask:0xf bank_mask:0xf
    v_dot2c_f32_bf16_dpp v54, v46, v147 row_newbcast:4 row_mask:0xf bank_mask:0xf
    v_dot2c_f32_bf16_dpp v55, v47, v147 row_newbcast:4 row_mask:0xf bank_mask:0xf
    v_dot2c_f32_bf16_dpp v48, v46, v148 row_newbcast:5 row_mask:0xf bank_mask:0xf
    v_dot2c_f32_bf16_dpp v49, v47, v148 row_newbcast:5 row_mask:0xf bank_mask:0xf
    v_dot2c_f32_bf16_dpp v50, v46, v149 row_newbcast:5 row_mask:0xf bank_mask:0xf
    v_dot2c_f32_bf16_dpp v51, v47, v149 row_newbcast:5 row_mask:0xf bank_mask:0xf
    v_dot2c_f32_bf16_dpp v52, v46, v150 row_newbcast:5 row_mask:0xf bank_mask:0xf
    v_dot2c_f32_bf16_dpp v53, v47, v150 row_newbcast:5 row_mask:0xf bank_mask:0xf
    v_dot2c_f32_bf16_dpp v54, v46, v151 row_newbcast:5 row_mask:0xf bank_mask:0xf
    v_dot2c_f32_bf16_dpp v55, v47, v151 row_newbcast:5 row_mask:0xf bank_mask:0xf
    v_dot2c_f32_bf16_dpp v48, v46, v152 row_newbcast:6 row_mask:0xf bank_mask:0xf
    v_dot2c_f32_bf16_dpp v49, v47, v152 row_newbcast:6 row_mask:0xf bank_mask:0xf
    v_dot2c_f32_bf16_dpp v50, v46, v153 row_newbcast:6 row_mask:0xf bank_mask:0xf
    v_dot2c_f32_bf16_dpp v51, v47, v153 row_newbcast:6 row_mask:0xf bank_mask:0xf
    v_dot2c_f32_bf16_dpp v52, v46, v154 row_newbcast:6 row_mask:0xf bank_mask:0xf
    v_dot2c_f32_bf16_dpp v53, v47, v154 row_newbcast:6 row_mask:0xf bank_mask:0xf
    v_dot2c_f32_bf16_dpp v54, v46, v155 row_newbcast:6 row_mask:0xf bank_mask:0xf
    v_dot2c_f32_bf16_dpp v55, v47, v155 row_newbcast:6 row_mask:0xf bank_mask:0xf
    v_dot2c_f32_bf16_dpp v48, v46, v156 row_newbcast:7 row_mask:0xf bank_mask:0xf
    v_dot2c_f32_bf16_dpp v49, v47, v156 row_newbcast:7 row_mask:0xf bank_mask:0xf
    v_dot2c_f32_bf16_dpp v50, v46, v157 row_newbcast:7 row_mask:0xf bank_mask:0xf
    v_dot2c_f32_bf16_dpp v51, v47, v157 row_newbcast:7 row_mask:0xf bank_mask:0xf
    v_dot2c_f32_bf16_dpp v52, v46, v158 row_newbcast:7 row_mask:0xf bank_mask:0xf
    v_dot2c_f32_bf16_dpp v53, v47, v158 row_newbcast:7 row_mask:0xf bank_mask:0xf
    v_dot2c_f32_bf16_dpp v54, v46, v159 row_newbcast:7 row_mask:0xf bank_mask:0xf
    v_dot2c_f32_bf16_dpp v55, v47, v159 row_newbcast:7 row_mask:0xf bank_mask:0xf
    v_dot2c_f32_bf16_dpp v48, v46, v160 row_newbcast:8 row_mask:0xf bank_mask:0xf
    v_dot2c_f32_bf16_dpp v49, v47, v160 row_newbcast:8 row_mask:0xf bank_mask:0xf
    v_dot2c_f32_bf16_dpp v50, v46, v161 row_newbcast:8 row_mask:0xf bank_mask:0xf
    v_dot2c_f32_bf16_dpp v51, v47, v161 row_newbcast:8 row_mask:0xf bank_mask:0xf
    v_dot2c_f32_bf16_dpp v52, v46, v162 row_newbcast:8 row_mask:0xf bank_mask:0xf
    v_dot2c_f32_bf16_dpp v53, v47, v162 row_newbcast:8 row_mask:0xf bank_mask:0xf
    v_dot2c_f32_bf16_dpp v54, v46, v163 row_newbcast:8 row_mask:0xf bank_mask:0xf
    v_dot2c_f32_bf16_dpp v55, v47, v163 row_newbcast:8 row_mask:0xf bank_mask:0xf
    v_dot2c_f32_bf16_dpp v48, v46, v164 row_newbcast:9 row_mask:0xf bank_mask:0xf
    v_dot2c_f32_bf16_dpp v49, v47, v164 row_newbcast:9 row_mask:0xf bank_mask:0xf
    v_dot2c_f32_bf16_dpp v50, v46, v165 row_newbcast:9 row_mask:0xf bank_mask:0xf
    v_dot2c_f32_bf16_dpp v51, v47, v165 row_newbcast:9 row_mask:0xf bank_mask:0xf
    v_dot2c_f32_bf16_dpp v52, v46, v166 row_newbcast:9 row_mask:0xf bank_mask:0xf
    v_dot2c_f32_bf16_dpp v53, v47, v166 row_newbcast:9 row_mask:0xf bank_mask:0xf
    v_dot2c_f32_bf16_dpp v54, v46, v167 row_newbcast:9 row_mask:0xf bank_mask:0xf
    v_dot2c_f32_bf16_dpp v55, v47, v167 row_newbcast:9 row_mask:0xf bank_mask:0xf
    v_dot2c_f32_bf16_dpp v48, v46, v168 row_newbcast:10 row_mask:0xf bank_mask:0xf
    v_dot2c_f32_bf16_dpp v49, v47, v168 row_newbcast:10 row_mask:0xf bank_mask:0xf
    v_dot2c_f32_bf16_dpp v50, v46, v169 row_newbcast:10 row_mask:0xf bank_mask:0xf
    v_dot2c_f32_bf16_dpp v51, v47, v169 row_newbcast:10 row_mask:0xf bank_mask:0xf
    v_dot2c_f32_bf16_dpp v52, v46, v170 row_newbcast:10 row_mask:0xf bank_mask:0xf
    v_dot2c_f32_bf16_dpp v53, v47, v170 row_newbcast:10 row_mask:0xf bank_mask:0xf
    v_dot2c_f32_bf16_dpp v54, v46, v171 row_newbcast:10 row_mask:0xf bank_mask:0xf
    v_dot2c_f32_bf16_dpp v55, v47, v171 row_newbcast:10 row_mask:0xf bank_mask:0xf
    v_dot2c_f32_bf16_dpp v48, v46, v172 row_newbcast:11 row_mask:0xf bank_mask:0xf
    v_dot2c_f32_bf16_dpp v49, v47, v172 row_newbcast:11 row_mask:0xf bank_mask:0xf
    v_dot2c_f32_bf16_dpp v50, v46, v173 row_newbcast:11 row_mask:0xf bank_mask:0xf
    v_dot2c_f32_bf16_dpp v51, v47, v173 row_newbcast:11 row_mask:0xf bank_mask:0xf
    v_dot2c_f32_bf16_dpp v52, v46, v174 row_newbcast:11 row_mask:0xf bank_mask:0xf
    v_dot2c_f32_bf16_dpp v53, v47, v174 row_newbcast:11 row_mask:0xf bank_mask:0xf
    v_dot2c_f32_bf16_dpp v54, v46, v175 row_newbcast:11 row_mask:0xf bank_mask:0xf
    v_dot2c_f32_bf16_dpp v55, v47, v175 row_newbcast:11 row_mask:0xf bank_mask:0xf
    v_dot2c_f32_bf16_dpp v48, v46, v176 row_newbcast:12 row_mask:0xf bank_mask:0xf
    v_dot2c_f32_bf16_dpp v49, v47, v176 row_newbcast:12 row_mask:0xf bank_mask:0xf
    v_dot2c_f32_bf16_dpp v50, v46, v177 row_newbcast:12 row_mask:0xf bank_mask:0xf
    v_dot2c_f32_bf16_dpp v51, v47, v177 row_newbcast:12 row_mask:0xf bank_mask:0xf
    v_dot2c_f32_bf16_dpp v52, v46, v178 row_newbcast:12 row_mask:0xf bank_mask:0xf
    v_dot2c_f32_bf16_dpp v53, v47, v178 row_newbcast:12 row_mask:0xf bank_mask:0xf
    v_dot2c_f32_bf16_dpp v54, v46, v179 row_newbcast:12 row_mask:0xf bank_mask:0xf
    v_dot2c_f32_bf16_dpp v55, v47, v179 row_newbcast:12 row_mask:0xf bank_mask:0xf
    v_dot2c_f32_bf16_dpp v48, v46, v180 row_newbcast:13 row_mask:0xf bank_mask:0xf
    v_dot2c_f32_bf16_dpp v49, v47, v180 row_newbcast:13 row_mask:0xf bank_mask:0xf
    v_dot2c_f32_bf16_dpp v50, v46, v181 row_newbcast:13 row_mask:0xf bank_mask:0xf
    v_dot2c_f32_bf16_dpp v51, v47, v181 row_newbcast:13 row_mask:0xf bank_mask:0xf
    v_dot2c_f32_bf16_dpp v52, v46, v182 row_newbcast:13 row_mask:0xf bank_mask:0xf
    v_dot2c_f32_bf16_dpp v53, v47, v182 row_newbcast:13 row_mask:0xf bank_mask:0xf
    v_dot2c_f32_bf16_dpp v54, v46, v183 row_newbcast:13 row_mask:0xf bank_mask:0xf
    v_dot2c_f32_bf16_dpp v55, v47, v183 row_newbcast:13 row_mask:0xf bank_mask:0xf
    v_dot2c_f32_bf16_dpp v48, v46, v184 row_newbcast:14 row_mask:0xf bank_mask:0xf
    v_dot2c_f32_bf16_dpp v49, v47, v184 row_newbcast:14 row_mask:0xf bank_mask:0xf
    v_dot2c_f32_bf16_dpp v50, v46, v185 row_newbcast:14 row_mask:0xf bank_mask:0xf
    v_dot2c_f32_bf16_dpp v51, v47, v185 row_newbcast:14 row_mask:0xf bank_mask:0xf
    v_dot2c_f32_bf16_dpp v52, v46, v186 row_newbcast:14 row_mask:0xf bank_mask:0xf
    v_dot2c_f32_bf16_dpp v53, v47, v186 row_newbcast:14 row_mask:0xf bank_mask:0xf
    v_dot2c_f32_bf16_dpp v54, v46, v187 row_newbcast:14 row_mask:0xf bank_mask:0xf
    v_dot2c_f32_bf16_dpp v55, v47, v187 row_newbcast:14 row_mask:0xf bank_mask:0xf
    v_dot2c_f32_bf16_dpp v48, v46, v188 row_newbcast:15 row_mask:0xf bank_mask:0xf
    v_dot2c_f32_bf16_dpp v49, v47, v188 row_newbcast:15 row_mask:0xf bank_mask:0xf
    v_dot2c_f32_bf16_dpp v50, v46, v189 row_newbcast:15 row_mask:0xf bank_mask:0xf
    v_dot2c_f32_bf16_dpp v51, v47, v189 row_newbcast:15 row_mask:0xf bank_mask:0xf
    v_dot2c_f32_bf16_dpp v52, v46, v190 row_newbcast:15 row_mask:0xf bank_mask:0xf
    v_dot2c_f32_bf16_dpp v53, v47, v190 row_newbcast:15 row_mask:0xf bank_mask:0xf
    v_dot2c_f32_bf16_dpp v54, v46, v191 row_newbcast:15 row_mask:0xf bank_mask:0xf
    v_dot2c_f32_bf16_dpp v55, v47, v191 row_newbcast:15 row_mask:0xf bank_mask:0xf
    s_lshl_b32 s39, s36, 2
    v_mov_b32 v26, s39
    ds_write_b32 v26, v57 offset:33024
    s_waitcnt lgkmcnt(0)
    s_barrier
    v_mov_b32 v26, 0
    ds_read_b128 v[16:19], v26 offset:33024
    ds_read_b128 v[20:23], v26 offset:33040
    s_waitcnt lgkmcnt(0)
    v_max3_f32 v24, v16, v17, v18
    v_max3_f32 v24, v24, v19, v20
    v_max3_f32 v24, v24, v21, v22
    v_max_f32 v24, v24, v23
    v_sub_f32 v25, v57, v24
    v_mul_f32 v25, 0x3fb8aa3b, v25
    v_exp_f32 v25, v25
    s_nop 0
    v_mul_f32 v48, v48, v25
    v_mul_f32 v49, v49, v25
    v_mul_f32 v50, v50, v25
    v_mul_f32 v51, v51, v25
    v_mul_f32 v52, v52, v25
    v_mul_f32 v53, v53, v25
    v_mul_f32 v54, v54, v25
    v_mul_f32 v55, v55, v25
    v_mul_f32 v56, v56, v25
    v_lshlrev_b32 v26, 5, v0
    ds_write_b128 v26, v[48:51] offset:16384
    ds_write_b128 v26, v[52:55] offset:16400
    v_lshlrev_b32 v59, 2, v0
    ds_write_b32 v59, v56 offset:33280
    s_waitcnt lgkmcnt(0)
    s_barrier
    s_lshl_b32 s39, s34, 3
    s_add_u32 s39, s39, s35
    s_cmp_eq_u32 s36, 2
    s_cbranch_scc1 L_attn_sumL
    s_cmp_ge_u32 s36, 2
    s_cbranch_scc1 L_attn_fin
    ds_read_b32 v16, v59 offset:16384
    ds_read_b32 v17, v59 offset:16896
    ds_read_b32 v18, v59 offset:17408
    ds_read_b32 v19, v59 offset:17920
    ds_read_b32 v20, v59 offset:18432
    ds_read_b32 v21, v59 offset:18944
    ds_read_b32 v22, v59 offset:19456
    ds_read_b32 v23, v59 offset:19968
    ds_read_b32 v24, v59 offset:20480
    ds_read_b32 v25, v59 offset:20992
    ds_read_b32 v26, v59 offset:21504
    ds_read_b32 v27, v59 offset:22016
    ds_read_b32 v28, v59 offset:22528
    ds_read_b32 v29, v59 offset:23040
    ds_read_b32 v30, v59 offset:23552
    ds_read_b32 v31, v59 offset:24064
    s_waitcnt lgkmcnt(0)
    v_mov_b32 v57, v16
    v_add_f32 v57, v57, v17
    v_add_f32 v57, v57, v18
    v_add_f32 v57, v57, v19
    v_add_f32 v57, v57, v20
    v_add_f32 v57, v57, v21
    v_add_f32 v57, v57, v22
    v_add_f32 v57, v57, v23
    v_add_f32 v57, v57, v24
    v_add_f32 v57, v57, v25
    v_add_f32 v57, v57, v26
    v_add_f32 v57, v57, v27
    v_add_f32 v57, v57, v28
    v_add_f32 v57, v57, v29
    v_add_f32 v57, v57, v30
    v_add_f32 v57, v57, v31
    ds_read_b32 v16, v59 offset:24576
    ds_read_b32 v17, v59 offset:25088
    ds_read_b32 v18, v59 offset:25600
    ds_read_b32 v19, v59 offset:26112
    ds_read_b32 v20, v59 offset:26624
    ds_read_b32 v21, v59 offset:27136
    ds_read_b32 v22, v59 offset:27648
    ds_read_b32 v23, v59 offset:28160
    ds_read_b32 v24, v59 offset:28672
    ds_read_b32 v25, v59 offset:29184
    ds_read_b32 v26, v59 offset:29696
    ds_read_b32 v27, v59 offset:30208
    ds_read_b32 v28, v59 offset:30720
    ds_read_b32 v29, v59 offset:31232
    ds_read_b32 v30, v59 offset:31744
    ds_read_b32 v31, v59 offset:32256
    s_waitcnt lgkmcnt(0)
    v_add_f32 v57, v57, v16
    v_add_f32 v57, v57, v17
    v_add_f32 v57, v57, v18
    v_add_f32 v57, v57, v19
    v_add_f32 v57, v57, v20
    v_add_f32 v57, v57, v21
    v_add_f32 v57, v57, v22
    v_add_f32 v57, v57, v23
    v_add_f32 v57, v57, v24
    v_add_f32 v57, v57, v25
    v_add_f32 v57, v57, v26
    v_add_f32 v57, v57, v27
    v_add_f32 v57, v57, v28
    v_add_f32 v57, v57, v29
    v_add_f32 v57, v57, v30
    v_add_f32 v57, v57, v31
    s_lshl_b32 s40, s39, 9
    v_add_u32 v28, s40, v59
    buffer_store_dword v57, v28, s[20:23], 0 offen offset:0
    s_branch L_attn_fin
L_attn_sumL:
    s_nop 4
    v_lshlrev_b32 v26, 5, v1
    ds_read_b128 v[16:19], v26 offset:33280
    ds_read_b128 v[20:23], v26 offset:33296
    s_waitcnt lgkmcnt(0)
    v_add_f32 v25, v16, v17
    v_add_f32 v25, v25, v18
    v_add_f32 v25, v25, v19
    v_add_f32 v25, v25, v20
    v_add_f32 v25, v25, v21
    v_add_f32 v25, v25, v22
    v_add_f32 v25, v25, v23
    s_nop 1
    v_add_f32_dpp v25, v25, v25 row_ror:8 row_mask:0xf bank_mask:0xf
    s_nop 1
    v_add_f32_dpp v25, v25, v25 row_ror:4 row_mask:0xf bank_mask:0xf
    s_nop 1
    v_add_f32_dpp v25, v25, v25 row_ror:2 row_mask:0xf bank_mask:0xf
    s_nop 1
    v_add_f32_dpp v25, v25, v25 row_ror:1 row_mask:0xf bank_mask:0xf
    v_mov_b32 v26, v25
    s_nop 1
    v_permlane16_swap_b32 v25, v26
    v_add_f32 v25, v25, v26
    v_mov_b32 v26, v25
    s_nop 1
    v_permlane32_swap_b32 v25, v26
    v_add_f32 v25, v25, v26
    v_mov_b32 v26, 0
    s_lshl_b32 s40, s39, 3
    s_add_u32 s40, s40, 0x20000
    v_mov_b32 v26, s40
    v_cmp_eq_u32 vcc, 0, v1
    s_nop 0
    s_and_saveexec_b64 s[42:43], vcc
    buffer_store_dwordx2 v[24:25], v26, s[20:23], 0 offen
    s_or_b64 exec, exec, s[42:43]
L_attn_fin:
    s_nop 4
L_attn_end:
    s_nop 4
    s_endpgm
.globl wo_kernel
.p2align 8
.type wo_kernel,@function
wo_kernel:
    s_cmp_ge_u32 s2, 256
    s_cbranch_scc1 L_wo_end
    s_load_dwordx2 s[24:25], s[0:1], 32
    s_load_dwordx2 s[32:33], s[0:1], 88
    s_and_b32 s37, s2, 7
    s_lshr_b32 s38, s2, 3
    s_and_b32 s38, s38, 3
    s_lshl_b32 s34, s37, 2
    s_add_u32 s34, s34, s38
    s_lshr_b32 s35, s2, 5
    v_and_b32 v1, 63, v0
    v_lshrrev_b32 v5, 3, v0
    v_lshlrev_b32 v2, 10, v5
    v_and_b32 v6, 7, v0
    v_lshlrev_b32 v6, 4, v6
    v_add_u32 v2, v2, v6
    s_lshl_b32 s39, s34, 17
    s_lshl_b32 s40, s35, 7
    s_add_u32 s39, s39, s40
    v_add_u32 v2, s39, v2
    v_and_b32 v7, 127, v0
    v_lshlrev_b32 v3, 2, v7
    s_lshl_b32 s39, s34, 12
    v_add_u32 v3, s39, v3
    s_lshl_b32 s39, s34, 6
    s_add_u32 s39, s39, 0x20000
    v_mov_b32 v4, s39
    s_waitcnt lgkmcnt(0)
    s_mov_b32 s4, s24
    s_mov_b32 s5, s25
    s_mov_b32 s6, 0x400000
    s_mov_b32 s7, 0x00020000
    s_mov_b32 s20, s32
    s_mov_b32 s21, s33
    s_mov_b32 s22, 0x60000
    s_mov_b32 s23, 0x00020000
    s_mov_b32 s40, 0x0
    buffer_load_dwordx4 v[64:67], v2, s[4:7], s40 offen
    s_mov_b32 s40, 0x8000
    buffer_load_dwordx4 v[68:71], v2, s[4:7], s40 offen
    s_mov_b32 s40, 0x10000
    buffer_load_dwordx4 v[72:75], v2, s[4:7], s40 offen
    s_mov_b32 s40, 0x18000
    buffer_load_dwordx4 v[76:79], v2, s[4:7], s40 offen
    buffer_load_dwordx4 v[16:19], v4, s[20:23], 0 offen offset:0
    buffer_load_dwordx4 v[20:23], v4, s[20:23], 0 offen offset:16
    buffer_load_dwordx4 v[24:27], v4, s[20:23], 0 offen offset:32
    buffer_load_dwordx4 v[28:31], v4, s[20:23], 0 offen offset:48
    buffer_load_dword v32, v3, s[20:23], 0 offen offset:0
    buffer_load_dword v33, v3, s[20:23], 0 offen offset:512
    buffer_load_dword v34, v3, s[20:23], 0 offen offset:1024
    buffer_load_dword v35, v3, s[20:23], 0 offen offset:1536
    buffer_load_dword v36, v3, s[20:23], 0 offen offset:2048
    buffer_load_dword v37, v3, s[20:23], 0 offen offset:2560
    buffer_load_dword v38, v3, s[20:23], 0 offen offset:3072
    buffer_load_dword v39, v3, s[20:23], 0 offen offset:3584
    s_waitcnt vmcnt(0)
    v_max3_f32 v40, v16, v18, v20
    v_max3_f32 v40, v40, v22, v24
    v_max3_f32 v40, v40, v26, v28
    v_max_f32 v40, v40, v30
    v_mov_b32 v41, 0
    v_mov_b32 v42, 0
    v_sub_f32 v43, v16, v40
    v_mul_f32 v43, 0x3fb8aa3b, v43
    v_exp_f32 v43, v43
    s_nop 0
    v_fma_f32 v41, v43, v17, v41
    v_fma_f32 v42, v43, v32, v42
    v_sub_f32 v43, v18, v40
    v_mul_f32 v43, 0x3fb8aa3b, v43
    v_exp_f32 v43, v43
    s_nop 0
    v_fma_f32 v41, v43, v19, v41
    v_fma_f32 v42, v43, v33, v42
    v_sub_f32 v43, v20, v40
    v_mul_f32 v43, 0x3fb8aa3b, v43
    v_exp_f32 v43, v43
    s_nop 0
    v_fma_f32 v41, v43, v21, v41
    v_fma_f32 v42, v43, v34, v42
    v_sub_f32 v43, v22, v40
    v_mul_f32 v43, 0x3fb8aa3b, v43
    v_exp_f32 v43, v43
    s_nop 0
    v_fma_f32 v41, v43, v23, v41
    v_fma_f32 v42, v43, v35, v42
    v_sub_f32 v43, v24, v40
    v_mul_f32 v43, 0x3fb8aa3b, v43
    v_exp_f32 v43, v43
    s_nop 0
    v_fma_f32 v41, v43, v25, v41
    v_fma_f32 v42, v43, v36, v42
    v_sub_f32 v43, v26, v40
    v_mul_f32 v43, 0x3fb8aa3b, v43
    v_exp_f32 v43, v43
    s_nop 0
    v_fma_f32 v41, v43, v27, v41
    v_fma_f32 v42, v43, v37, v42
    v_sub_f32 v43, v28, v40
    v_mul_f32 v43, 0x3fb8aa3b, v43
    v_exp_f32 v43, v43
    s_nop 0
    v_fma_f32 v41, v43, v29, v41
    v_fma_f32 v42, v43, v38, v42
    v_sub_f32 v43, v30, v40
    v_mul_f32 v43, 0x3fb8aa3b, v43
    v_exp_f32 v43, v43
    s_nop 0
    v_fma_f32 v41, v43, v31, v41
    v_fma_f32 v42, v43, v39, v42
    v_rcp_f32 v44, v41
    s_nop 0
    v_mul_f32 v43, v42, v44
    v_fma_f32 v45, -v43, v41, v42
    v_fma_f32 v43, v45, v44, v43
    v_cvt_pk_bf16_f32 v43, v43, 0
    v_lshlrev_b32 v44, 2, v7
    ds_write_b32 v44, v43 offset:0
    s_waitcnt lgkmcnt(0)
    s_barrier
    v_lshlrev_b32 v44, 2, v5
    ds_read_b32 v46, v44 offset:0
    ds_read_b32 v47, v44 offset:128
    ds_read_b32 v48, v44 offset:256
    ds_read_b32 v49, v44 offset:384
    s_waitcnt lgkmcnt(0)
    v_lshlrev_b32 v50, 16, v46
    v_dot2_f32_bf16 v52, v46, v64, 0
    v_dot2_f32_bf16 v53, v50, v64, 0
    v_dot2_f32_bf16 v54, v46, v65, 0
    v_dot2_f32_bf16 v55, v50, v65, 0
    v_dot2_f32_bf16 v56, v46, v66, 0
    v_dot2_f32_bf16 v57, v50, v66, 0
    v_dot2_f32_bf16 v58, v46, v67, 0
    v_dot2_f32_bf16 v59, v50, v67, 0
    v_lshlrev_b32 v50, 16, v47
    v_dot2c_f32_bf16 v52, v47, v68
    v_dot2c_f32_bf16 v53, v50, v68
    v_dot2c_f32_bf16 v54, v47, v69
    v_dot2c_f32_bf16 v55, v50, v69
    v_dot2c_f32_bf16 v56, v47, v70
    v_dot2c_f32_bf16 v57, v50, v70
    v_dot2c_f32_bf16 v58, v47, v71
    v_dot2c_f32_bf16 v59, v50, v71
    v_lshlrev_b32 v50, 16, v48
    v_dot2c_f32_bf16 v52, v48, v72
    v_dot2c_f32_bf16 v53, v50, v72
    v_dot2c_f32_bf16 v54, v48, v73
    v_dot2c_f32_bf16 v55, v50, v73
    v_dot2c_f32_bf16 v56, v48, v74
    v_dot2c_f32_bf16 v57, v50, v74
    v_dot2c_f32_bf16 v58, v48, v75
    v_dot2c_f32_bf16 v59, v50, v75
    v_lshlrev_b32 v50, 16, v49
    v_dot2c_f32_bf16 v52, v49, v76
    v_dot2c_f32_bf16 v53, v50, v76
    v_dot2c_f32_bf16 v54, v49, v77
    v_dot2c_f32_bf16 v55, v50, v77
    v_dot2c_f32_bf16 v56, v49, v78
    v_dot2c_f32_bf16 v57, v50, v78
    v_dot2c_f32_bf16 v58, v49, v79
    v_dot2c_f32_bf16 v59, v50, v79
    v_add_f32_dpp v52, v52, v52 row_ror:8 row_mask:0xf bank_mask:0xf
    v_add_f32_dpp v53, v53, v53 row_ror:8 row_mask:0xf bank_mask:0xf
    v_add_f32_dpp v54, v54, v54 row_ror:8 row_mask:0xf bank_mask:0xf
    v_add_f32_dpp v55, v55, v55 row_ror:8 row_mask:0xf bank_mask:0xf
    v_add_f32_dpp v56, v56, v56 row_ror:8 row_mask:0xf bank_mask:0xf
    v_add_f32_dpp v57, v57, v57 row_ror:8 row_mask:0xf bank_mask:0xf
    v_add_f32_dpp v58, v58, v58 row_ror:8 row_mask:0xf bank_mask:0xf
    v_add_f32_dpp v59, v59, v59 row_ror:8 row_mask:0xf bank_mask:0xf
    v_lshrrev_b32 v44, 4, v0
    v_lshlrev_b32 v44, 8, v44
    v_lshlrev_b32 v45, 1, v6
    v_add_u32 v44, v44, v45
    ds_write_b128 v44, v[52:55] offset:1024
    ds_write_b128 v44, v[56:59] offset:1040
    s_waitcnt lgkmcnt(0)
    s_barrier
    v_cmp_gt_u32 vcc, 64, v0
    s_nop 0
    s_and_saveexec_b64 s[42:43], vcc
    s_cbranch_execz L_wo_restore
    v_lshlrev_b32 v44, 2, v0
    ds_read_b32 v16, v44 offset:1024
    ds_read_b32 v17, v44 offset:1280
    ds_read_b32 v18, v44 offset:1536
    ds_read_b32 v19, v44 offset:1792
    ds_read_b32 v20, v44 offset:2048
    ds_read_b32 v21, v44 offset:2304
    ds_read_b32 v22, v44 offset:2560
    ds_read_b32 v23, v44 offset:2816
    ds_read_b32 v24, v44 offset:3072
    ds_read_b32 v25, v44 offset:3328
    ds_read_b32 v26, v44 offset:3584
    ds_read_b32 v27, v44 offset:3840
    ds_read_b32 v28, v44 offset:4096
    ds_read_b32 v29, v44 offset:4352
    ds_read_b32 v30, v44 offset:4608
    ds_read_b32 v31, v44 offset:4864
    s_waitcnt lgkmcnt(0)
    v_add_f32 v45, v16, v17
    v_add_f32 v45, v45, v18
    v_add_f32 v45, v45, v19
    v_add_f32 v45, v45, v20
    v_add_f32 v45, v45, v21
    v_add_f32 v45, v45, v22
    v_add_f32 v45, v45, v23
    v_add_f32 v45, v45, v24
    v_add_f32 v45, v45, v25
    v_add_f32 v45, v45, v26
    v_add_f32 v45, v45, v27
    v_add_f32 v45, v45, v28
    v_add_f32 v45, v45, v29
    v_add_f32 v45, v45, v30
    v_add_f32 v45, v45, v31
    s_lshl_b32 s39, s34, 11
    s_lshl_b32 s40, s35, 8
    s_add_u32 s39, s39, s40
    s_add_u32 s39, s39, 0x40000
    v_add_u32 v44, s39, v44
    buffer_store_dword v45, v44, s[20:23], 0 offen
L_wo_restore:
    s_nop 4
    s_or_b64 exec, exec, s[42:43]
L_wo_end:
    s_nop 4
    s_endpgm
.globl ffn1_kernel
.p2align 8
.type ffn1_kernel,@function
ffn1_kernel:
    s_cmp_ge_u32 s2, 112
    s_cbranch_scc1 L_ffn1_end
    s_load_dwordx2 s[24:25], s[0:1], 0
    s_load_dwordx4 s[28:31], s[0:1], 48
    s_load_dwordx2 s[32:33], s[0:1], 88
    v_and_b32 v1, 63, v0
    v_lshrrev_b32 v5, 6, v0
    v_lshrrev_b32 v6, 1, v0
    v_mul_u32_u24 v2, 3584, v6
    v_and_b32 v7, 1, v0
    v_lshlrev_b32 v7, 4, v7
    v_add_u32 v2, v2, v7
    s_and_b32 s37, s2, 7
    s_mul_i32 s37, s37, 14
    s_lshr_b32 s38, s2, 3
    s_add_u32 s36, s37, s38
    s_lshl_b32 s39, s36, 5
    v_add_u32 v2, s39, v2
    v_lshlrev_b32 v3, 3, v0
    v_lshlrev_b32 v4, 2, v0
    s_waitcnt lgkmcnt(0)
    s_mov_b32 s4, s24
    s_mov_b32 s5, s25
    s_mov_b32 s6, 0x400
    s_mov_b32 s7, 0x00020000
    s_mov_b32 s8, s28
    s_mov_b32 s9, s29
    s_mov_b32 s10, 0x1c0000
    s_mov_b32 s11, 0x00020000
    s_mov_b32 s12, s30
    s_mov_b32 s13, s31
    s_mov_b32 s14, 0x1c0000
    s_mov_b32 s15, 0x00020000
    s_mov_b32 s20, s32
    s_mov_b32 s21, s33
    s_mov_b32 s22, 0x60000
    s_mov_b32 s23, 0x00020000
    s_mov_b32 s40, 0x0
    buffer_load_dwordx4 v[64:67], v2, s[8:11], s40 offen
    buffer_load_dwordx4 v[80:83], v2, s[12:15], s40 offen
    s_mov_b32 s40, 0x70000
    buffer_load_dwordx4 v[68:71], v2, s[8:11], s40 offen
    buffer_load_dwordx4 v[84:87], v2, s[12:15], s40 offen
    s_mov_b32 s40, 0xe0000
    buffer_load_dwordx4 v[72:75], v2, s[8:11], s40 offen
    buffer_load_dwordx4 v[88:91], v2, s[12:15], s40 offen
    s_mov_b32 s40, 0x150000
    buffer_load_dwordx4 v[76:79], v2, s[8:11], s40 offen
    buffer_load_dwordx4 v[92:95], v2, s[12:15], s40 offen
    s_mov_b32 s40, 0x40000
    buffer_load_dwordx2 v[96:97], v3, s[20:23], s40 offen
    s_mov_b32 s40, 0x40800
    buffer_load_dwordx2 v[98:99], v3, s[20:23], s40 offen
    s_mov_b32 s40, 0x41000
    buffer_load_dwordx2 v[100:101], v3, s[20:23], s40 offen
    s_mov_b32 s40, 0x41800
    buffer_load_dwordx2 v[102:103], v3, s[20:23], s40 offen
    s_mov_b32 s40, 0x42000
    buffer_load_dwordx2 v[104:105], v3, s[20:23], s40 offen
    s_mov_b32 s40, 0x42800
    buffer_load_dwordx2 v[106:107], v3, s[20:23], s40 offen
    s_mov_b32 s40, 0x43000
    buffer_load_dwordx2 v[108:109], v3, s[20:23], s40 offen
    s_mov_b32 s40, 0x43800
    buffer_load_dwordx2 v[110:111], v3, s[20:23], s40 offen
    s_mov_b32 s40, 0x44000
    buffer_load_dwordx2 v[112:113], v3, s[20:23], s40 offen
    s_mov_b32 s40, 0x44800
    buffer_load_dwordx2 v[114:115], v3, s[20:23], s40 offen
    s_mov_b32 s40, 0x45000
    buffer_load_dwordx2 v[116:117], v3, s[20:23], s40 offen
    s_mov_b32 s40, 0x45800
    buffer_load_dwordx2 v[118:119], v3, s[20:23], s40 offen
    s_mov_b32 s40, 0x46000
    buffer_load_dwordx2 v[120:121], v3, s[20:23], s40 offen
    s_mov_b32 s40, 0x46800
    buffer_load_dwordx2 v[122:123], v3, s[20:23], s40 offen
    s_mov_b32 s40, 0x47000
    buffer_load_dwordx2 v[124:125], v3, s[20:23], s40 offen
    s_mov_b32 s40, 0x47800
    buffer_load_dwordx2 v[126:127], v3, s[20:23], s40 offen
    s_mov_b32 s40, 0x48000
    buffer_load_dwordx2 v[128:129], v3, s[20:23], s40 offen
    s_mov_b32 s40, 0x48800
    buffer_load_dwordx2 v[130:131], v3, s[20:23], s40 offen
    s_mov_b32 s40, 0x49000
    buffer_load_dwordx2 v[132:133], v3, s[20:23], s40 offen
    s_mov_b32 s40, 0x49800
    buffer_load_dwordx2 v[134:135], v3, s[20:23], s40 offen
    s_mov_b32 s40, 0x4a000
    buffer_load_dwordx2 v[136:137], v3, s[20:23], s40 offen
    s_mov_b32 s40, 0x4a800
    buffer_load_dwordx2 v[138:139], v3, s[20:23], s40 offen
    s_mov_b32 s40, 0x4b000
    buffer_load_dwordx2 v[140:141], v3, s[20:23], s40 offen
    s_mov_b32 s40, 0x4b800
    buffer_load_dwordx2 v[142:143], v3, s[20:23], s40 offen
    s_mov_b32 s40, 0x4c000
    buffer_load_dwordx2 v[144:145], v3, s[20:23], s40 offen
    s_mov_b32 s40, 0x4c800
    buffer_load_dwordx2 v[146:147], v3, s[20:23], s40 offen
    s_mov_b32 s40, 0x4d000
    buffer_load_dwordx2 v[148:149], v3, s[20:23], s40 offen
    s_mov_b32 s40, 0x4d800
    buffer_load_dwordx2 v[150:151], v3, s[20:23], s40 offen
    s_mov_b32 s40, 0x4e000
    buffer_load_dwordx2 v[152:153], v3, s[20:23], s40 offen
    s_mov_b32 s40, 0x4e800
    buffer_load_dwordx2 v[154:155], v3, s[20:23], s40 offen
    s_mov_b32 s40, 0x4f000
    buffer_load_dwordx2 v[156:157], v3, s[20:23], s40 offen
    s_mov_b32 s40, 0x4f800
    buffer_load_dwordx2 v[158:159], v3, s[20:23], s40 offen
    buffer_load_dword v8, v4, s[4:7], 0 offen
    s_waitcnt vmcnt(0)
    v_add_f32 v10, v96, v98
    v_add_f32 v11, v97, v99
    v_add_f32 v10, v10, v100
    v_add_f32 v11, v11, v101
    v_add_f32 v10, v10, v102
    v_add_f32 v11, v11, v103
    v_add_f32 v10, v10, v104
    v_add_f32 v11, v11, v105
    v_add_f32 v10, v10, v106
    v_add_f32 v11, v11, v107
    v_add_f32 v10, v10, v108
    v_add_f32 v11, v11, v109
    v_add_f32 v10, v10, v110
    v_add_f32 v11, v11, v111
    v_add_f32 v10, v10, v112
    v_add_f32 v11, v11, v113
    v_add_f32 v10, v10, v114
    v_add_f32 v11, v11, v115
    v_add_f32 v10, v10, v116
    v_add_f32 v11, v11, v117
    v_add_f32 v10, v10, v118
    v_add_f32 v11, v11, v119
    v_add_f32 v10, v10, v120
    v_add_f32 v11, v11, v121
    v_add_f32 v10, v10, v122
    v_add_f32 v11, v11, v123
    v_add_f32 v10, v10, v124
    v_add_f32 v11, v11, v125
    v_add_f32 v10, v10, v126
    v_add_f32 v11, v11, v127
    v_add_f32 v10, v10, v128
    v_add_f32 v11, v11, v129
    v_add_f32 v10, v10, v130
    v_add_f32 v11, v11, v131
    v_add_f32 v10, v10, v132
    v_add_f32 v11, v11, v133
    v_add_f32 v10, v10, v134
    v_add_f32 v11, v11, v135
    v_add_f32 v10, v10, v136
    v_add_f32 v11, v11, v137
    v_add_f32 v10, v10, v138
    v_add_f32 v11, v11, v139
    v_add_f32 v10, v10, v140
    v_add_f32 v11, v11, v141
    v_add_f32 v10, v10, v142
    v_add_f32 v11, v11, v143
    v_add_f32 v10, v10, v144
    v_add_f32 v11, v11, v145
    v_add_f32 v10, v10, v146
    v_add_f32 v11, v11, v147
    v_add_f32 v10, v10, v148
    v_add_f32 v11, v11, v149
    v_add_f32 v10, v10, v150
    v_add_f32 v11, v11, v151
    v_add_f32 v10, v10, v152
    v_add_f32 v11, v11, v153
    v_add_f32 v10, v10, v154
    v_add_f32 v11, v11, v155
    v_add_f32 v10, v10, v156
    v_add_f32 v11, v11, v157
    v_add_f32 v10, v10, v158
    v_add_f32 v11, v11, v159
    v_cvt_pk_bf16_f32 v10, v10, v10
    v_lshlrev_b32 v10, 16, v10
    v_cvt_pk_bf16_f32 v11, v11, v11
    v_lshlrev_b32 v11, 16, v11
    v_lshlrev_b32 v12, 16, v8
    v_and_b32 v13, 0xffff0000, v8
    v_add_f32 v10, v12, v10
    v_add_f32 v11, v13, v11
    v_cvt_pk_bf16_f32 v10, v10, v10
    v_lshlrev_b32 v10, 16, v10
    v_cvt_pk_bf16_f32 v11, v11, v11
    v_lshlrev_b32 v11, 16, v11
    s_mov_b32 s41, 0x50000
    s_cmp_lg_u32 s2, 0
    s_cbranch_scc1 L_ffn1_noh
    buffer_store_dwordx2 v[10:11], v3, s[20:23], s41 offen
L_ffn1_noh:
    s_nop 4
    v_add_f32 v14, v10, v11
    s_nop 1
    v_add_f32_dpp v14, v14, v14 row_ror:8 row_mask:0xf bank_mask:0xf
    s_nop 1
    v_add_f32_dpp v14, v14, v14 row_ror:4 row_mask:0xf bank_mask:0xf
    s_nop 1
    v_add_f32_dpp v14, v14, v14 row_ror:2 row_mask:0xf bank_mask:0xf
    s_nop 1
    v_add_f32_dpp v14, v14, v14 row_ror:1 row_mask:0xf bank_mask:0xf
    v_mov_b32 v15, v14
    s_nop 1
    v_permlane16_swap_b32 v14, v15
    v_add_f32 v14, v14, v15
    v_mov_b32 v15, v14
    s_nop 1
    v_permlane32_swap_b32 v14, v15
    v_add_f32 v14, v14, v15
    v_lshlrev_b32 v15, 2, v5
    ds_write_b32 v15, v14 offset:2048
    s_waitcnt lgkmcnt(0)
    s_barrier
    v_mov_b32 v15, 0
    ds_read_b128 v[60:63], v15 offset:2048
    s_waitcnt lgkmcnt(0)
    v_add_f32 v14, v60, v61
    v_add_f32 v14, v14, v62
    v_add_f32 v14, v14, v63
    v_mul_f32 v14, 0x3b000000, v14
    v_sub_f32 v15, v10, v14
    v_sub_f32 v16, v11, v14
    v_mul_f32 v17, v15, v15
    v_fma_f32 v17, v16, v16, v17
    s_nop 1
    v_add_f32_dpp v17, v17, v17 row_ror:8 row_mask:0xf bank_mask:0xf
    s_nop 1
    v_add_f32_dpp v17, v17, v17 row_ror:4 row_mask:0xf bank_mask:0xf
    s_nop 1
    v_add_f32_dpp v17, v17, v17 row_ror:2 row_mask:0xf bank_mask:0xf
    s_nop 1
    v_add_f32_dpp v17, v17, v17 row_ror:1 row_mask:0xf bank_mask:0xf
    v_mov_b32 v15, v17
    s_nop 1
    v_permlane16_swap_b32 v17, v15
    v_add_f32 v17, v17, v15
    v_mov_b32 v15, v17
    s_nop 1
    v_permlane32_swap_b32 v17, v15
    v_add_f32 v17, v17, v15
    v_lshlrev_b32 v15, 2, v5
    ds_write_b32 v15, v17 offset:2064
    s_waitcnt lgkmcnt(0)
    s_barrier
    v_mov_b32 v15, 0
    ds_read_b128 v[60:63], v15 offset:2064
    s_waitcnt lgkmcnt(0)
    v_add_f32 v17, v60, v61
    v_add_f32 v17, v17, v62
    v_add_f32 v17, v17, v63
    v_mul_f32 v17, 0x3b000000, v17
    v_cvt_pk_bf16_f32 v18, v14, v14
    v_lshlrev_b32 v18, 16, v18
    v_cvt_pk_bf16_f32 v19, v17, v17
    v_lshlrev_b32 v19, 16, v19
    v_add_f32 v19, 0x3727c5ac, v19
    v_cvt_pk_bf16_f32 v19, v19, v19
    v_lshlrev_b32 v19, 16, v19
    v_sqrt_f32 v19, v19
    s_nop 0
    v_cvt_pk_bf16_f32 v19, v19, v19
    v_lshlrev_b32 v19, 16, v19
    v_sub_f32 v20, v10, v18
    v_cvt_pk_bf16_f32 v20, v20, v20
    v_lshlrev_b32 v20, 16, v20
    v_rcp_f32 v22, v19
    s_nop 0
    v_mul_f32 v21, v20, v22
    v_fma_f32 v23, -v21, v19, v20
    v_fma_f32 v21, v23, v22, v21
    v_cvt_pk_bf16_f32 v24, v21, 0
    v_sub_f32 v20, v11, v18
    v_cvt_pk_bf16_f32 v20, v20, v20
    v_lshlrev_b32 v20, 16, v20
    v_rcp_f32 v22, v19
    s_nop 0
    v_mul_f32 v21, v20, v22
    v_fma_f32 v23, -v21, v19, v20
    v_fma_f32 v21, v23, v22, v21
    v_cvt_pk_bf16_f32 v25, v21, 0
    ds_write_b64 v3, v[24:25] offset:0
    s_waitcnt lgkmcnt(0)
    s_barrier
    v_lshlrev_b32 v26, 2, v6
    ds_read_b32 v28, v26 offset:0
    ds_read_b32 v29, v26 offset:512
    ds_read_b32 v30, v26 offset:1024
    ds_read_b32 v31, v26 offset:1536
    s_waitcnt lgkmcnt(0)
    v_lshlrev_b32 v27, 16, v28
    v_dot2_f32_bf16 v32, v28, v64, 0
    v_dot2_f32_bf16 v33, v27, v64, 0
    v_dot2_f32_bf16 v34, v28, v65, 0
    v_dot2_f32_bf16 v35, v27, v65, 0
    v_dot2_f32_bf16 v36, v28, v66, 0
    v_dot2_f32_bf16 v37, v27, v66, 0
    v_dot2_f32_bf16 v38, v28, v67, 0
    v_dot2_f32_bf16 v39, v27, v67, 0
    v_dot2_f32_bf16 v40, v28, v80, 0
    v_dot2_f32_bf16 v41, v27, v80, 0
    v_dot2_f32_bf16 v42, v28, v81, 0
    v_dot2_f32_bf16 v43, v27, v81, 0
    v_dot2_f32_bf16 v44, v28, v82, 0
    v_dot2_f32_bf16 v45, v27, v82, 0
    v_dot2_f32_bf16 v46, v28, v83, 0
    v_dot2_f32_bf16 v47, v27, v83, 0
    v_lshlrev_b32 v27, 16, v29
    v_dot2c_f32_bf16 v32, v29, v68
    v_dot2c_f32_bf16 v33, v27, v68
    v_dot2c_f32_bf16 v34, v29, v69
    v_dot2c_f32_bf16 v35, v27, v69
    v_dot2c_f32_bf16 v36, v29, v70
    v_dot2c_f32_bf16 v37, v27, v70
    v_dot2c_f32_bf16 v38, v29, v71
    v_dot2c_f32_bf16 v39, v27, v71
    v_dot2c_f32_bf16 v40, v29, v84
    v_dot2c_f32_bf16 v41, v27, v84
    v_dot2c_f32_bf16 v42, v29, v85
    v_dot2c_f32_bf16 v43, v27, v85
    v_dot2c_f32_bf16 v44, v29, v86
    v_dot2c_f32_bf16 v45, v27, v86
    v_dot2c_f32_bf16 v46, v29, v87
    v_dot2c_f32_bf16 v47, v27, v87
    v_lshlrev_b32 v27, 16, v30
    v_dot2c_f32_bf16 v32, v30, v72
    v_dot2c_f32_bf16 v33, v27, v72
    v_dot2c_f32_bf16 v34, v30, v73
    v_dot2c_f32_bf16 v35, v27, v73
    v_dot2c_f32_bf16 v36, v30, v74
    v_dot2c_f32_bf16 v37, v27, v74
    v_dot2c_f32_bf16 v38, v30, v75
    v_dot2c_f32_bf16 v39, v27, v75
    v_dot2c_f32_bf16 v40, v30, v88
    v_dot2c_f32_bf16 v41, v27, v88
    v_dot2c_f32_bf16 v42, v30, v89
    v_dot2c_f32_bf16 v43, v27, v89
    v_dot2c_f32_bf16 v44, v30, v90
    v_dot2c_f32_bf16 v45, v27, v90
    v_dot2c_f32_bf16 v46, v30, v91
    v_dot2c_f32_bf16 v47, v27, v91
    v_lshlrev_b32 v27, 16, v31
    v_dot2c_f32_bf16 v32, v31, v76
    v_dot2c_f32_bf16 v33, v27, v76
    v_dot2c_f32_bf16 v34, v31, v77
    v_dot2c_f32_bf16 v35, v27, v77
    v_dot2c_f32_bf16 v36, v31, v78
    v_dot2c_f32_bf16 v37, v27, v78
    v_dot2c_f32_bf16 v38, v31, v79
    v_dot2c_f32_bf16 v39, v27, v79
    v_dot2c_f32_bf16 v40, v31, v92
    v_dot2c_f32_bf16 v41, v27, v92
    v_dot2c_f32_bf16 v42, v31, v93
    v_dot2c_f32_bf16 v43, v27, v93
    v_dot2c_f32_bf16 v44, v31, v94
    v_dot2c_f32_bf16 v45, v27, v94
    v_dot2c_f32_bf16 v46, v31, v95
    v_dot2c_f32_bf16 v47, v27, v95
    v_add_f32_dpp v32, v32, v32 quad_perm:[2,3,0,1] row_mask:0xf bank_mask:0xf
    v_add_f32_dpp v33, v33, v33 quad_perm:[2,3,0,1] row_mask:0xf bank_mask:0xf
    v_add_f32_dpp v34, v34, v34 quad_perm:[2,3,0,1] row_mask:0xf bank_mask:0xf
    v_add_f32_dpp v35, v35, v35 quad_perm:[2,3,0,1] row_mask:0xf bank_mask:0xf
    v_add_f32_dpp v36, v36, v36 quad_perm:[2,3,0,1] row_mask:0xf bank_mask:0xf
    v_add_f32_dpp v37, v37, v37 quad_perm:[2,3,0,1] row_mask:0xf bank_mask:0xf
    v_add_f32_dpp v38, v38, v38 quad_perm:[2,3,0,1] row_mask:0xf bank_mask:0xf
    v_add_f32_dpp v39, v39, v39 quad_perm:[2,3,0,1] row_mask:0xf bank_mask:0xf
    v_add_f32_dpp v40, v40, v40 quad_perm:[2,3,0,1] row_mask:0xf bank_mask:0xf
    v_add_f32_dpp v41, v41, v41 quad_perm:[2,3,0,1] row_mask:0xf bank_mask:0xf
    v_add_f32_dpp v42, v42, v42 quad_perm:[2,3,0,1] row_mask:0xf bank_mask:0xf
    v_add_f32_dpp v43, v43, v43 quad_perm:[2,3,0,1] row_mask:0xf bank_mask:0xf
    v_add_f32_dpp v44, v44, v44 quad_perm:[2,3,0,1] row_mask:0xf bank_mask:0xf
    v_add_f32_dpp v45, v45, v45 quad_perm:[2,3,0,1] row_mask:0xf bank_mask:0xf
    v_add_f32_dpp v46, v46, v46 quad_perm:[2,3,0,1] row_mask:0xf bank_mask:0xf
    v_add_f32_dpp v47, v47, v47 quad_perm:[2,3,0,1] row_mask:0xf bank_mask:0xf
    v_add_f32_dpp v32, v32, v32 row_ror:4 row_mask:0xf bank_mask:0xf
    v_add_f32_dpp v33, v33, v33 row_ror:4 row_mask:0xf bank_mask:0xf
    v_add_f32_dpp v34, v34, v34 row_ror:4 row_mask:0xf bank_mask:0xf
    v_add_f32_dpp v35, v35, v35 row_ror:4 row_mask:0xf bank_mask:0xf
    v_add_f32_dpp v36, v36, v36 row_ror:4 row_mask:0xf bank_mask:0xf
    v_add_f32_dpp v37, v37, v37 row_ror:4 row_mask:0xf bank_mask:0xf
    v_add_f32_dpp v38, v38, v38 row_ror:4 row_mask:0xf bank_mask:0xf
    v_add_f32_dpp v39, v39, v39 row_ror:4 row_mask:0xf bank_mask:0xf
    v_add_f32_dpp v40, v40, v40 row_ror:4 row_mask:0xf bank_mask:0xf
    v_add_f32_dpp v41, v41, v41 row_ror:4 row_mask:0xf bank_mask:0xf
    v_add_f32_dpp v42, v42, v42 row_ror:4 row_mask:0xf bank_mask:0xf
    v_add_f32_dpp v43, v43, v43 row_ror:4 row_mask:0xf bank_mask:0xf
    v_add_f32_dpp v44, v44, v44 row_ror:4 row_mask:0xf bank_mask:0xf
    v_add_f32_dpp v45, v45, v45 row_ror:4 row_mask:0xf bank_mask:0xf
    v_add_f32_dpp v46, v46, v46 row_ror:4 row_mask:0xf bank_mask:0xf
    v_add_f32_dpp v47, v47, v47 row_ror:4 row_mask:0xf bank_mask:0xf
    v_add_f32_dpp v32, v32, v32 row_ror:8 row_mask:0xf bank_mask:0xf
    v_add_f32_dpp v33, v33, v33 row_ror:8 row_mask:0xf bank_mask:0xf
    v_add_f32_dpp v34, v34, v34 row_ror:8 row_mask:0xf bank_mask:0xf
    v_add_f32_dpp v35, v35, v35 row_ror:8 row_mask:0xf bank_mask:0xf
    v_add_f32_dpp v36, v36, v36 row_ror:8 row_mask:0xf bank_mask:0xf
    v_add_f32_dpp v37, v37, v37 row_ror:8 row_mask:0xf bank_mask:0xf
    v_add_f32_dpp v38, v38, v38 row_ror:8 row_mask:0xf bank_mask:0xf
    v_add_f32_dpp v39, v39, v39 row_ror:8 row_mask:0xf bank_mask:0xf
    v_add_f32_dpp v40, v40, v40 row_ror:8 row_mask:0xf bank_mask:0xf
    v_add_f32_dpp v41, v41, v41 row_ror:8 row_mask:0xf bank_mask:0xf
    v_add_f32_dpp v42, v42, v42 row_ror:8 row_mask:0xf bank_mask:0xf
    v_add_f32_dpp v43, v43, v43 row_ror:8 row_mask:0xf bank_mask:0xf
    v_add_f32_dpp v44, v44, v44 row_ror:8 row_mask:0xf bank_mask:0xf
    v_add_f32_dpp v45, v45, v45 row_ror:8 row_mask:0xf bank_mask:0xf
    v_add_f32_dpp v46, v46, v46 row_ror:8 row_mask:0xf bank_mask:0xf
    v_add_f32_dpp v47, v47, v47 row_ror:8 row_mask:0xf bank_mask:0xf
    v_lshrrev_b32 v26, 4, v0
    v_lshlrev_b32 v26, 7, v26
    v_lshlrev_b32 v27, 2, v7
    v_add_u32 v26, v26, v27
    ds_write_b128 v26, v[32:35] offset:4096
    ds_write_b128 v26, v[36:39] offset:4112
    ds_write_b128 v26, v[40:43] offset:4128
    ds_write_b128 v26, v[44:47] offset:4144
    s_waitcnt lgkmcnt(0)
    s_barrier
    v_cmp_gt_u32 vcc, 16, v0
    s_nop 0
    s_and_saveexec_b64 s[42:43], vcc
    s_cbranch_execz L_ffn1_restore
    v_lshrrev_b32 v26, 3, v0
    v_lshlrev_b32 v26, 6, v26
    v_and_b32 v27, 7, v0
    v_lshlrev_b32 v27, 2, v27
    v_add_u32 v26, v26, v27
    ds_read_b32 v96, v26 offset:4096
    ds_read_b32 v112, v26 offset:4128
    ds_read_b32 v97, v26 offset:4224
    ds_read_b32 v113, v26 offset:4256
    ds_read_b32 v98, v26 offset:4352
    ds_read_b32 v114, v26 offset:4384
    ds_read_b32 v99, v26 offset:4480
    ds_read_b32 v115, v26 offset:4512
    ds_read_b32 v100, v26 offset:4608
    ds_read_b32 v116, v26 offset:4640
    ds_read_b32 v101, v26 offset:4736
    ds_read_b32 v117, v26 offset:4768
    ds_read_b32 v102, v26 offset:4864
    ds_read_b32 v118, v26 offset:4896
    ds_read_b32 v103, v26 offset:4992
    ds_read_b32 v119, v26 offset:5024
    ds_read_b32 v104, v26 offset:5120
    ds_read_b32 v120, v26 offset:5152
    ds_read_b32 v105, v26 offset:5248
    ds_read_b32 v121, v26 offset:5280
    ds_read_b32 v106, v26 offset:5376
    ds_read_b32 v122, v26 offset:5408
    ds_read_b32 v107, v26 offset:5504
    ds_read_b32 v123, v26 offset:5536
    ds_read_b32 v108, v26 offset:5632
    ds_read_b32 v124, v26 offset:5664
    ds_read_b32 v109, v26 offset:5760
    ds_read_b32 v125, v26 offset:5792
    ds_read_b32 v110, v26 offset:5888
    ds_read_b32 v126, v26 offset:5920
    ds_read_b32 v111, v26 offset:6016
    ds_read_b32 v127, v26 offset:6048
    s_waitcnt lgkmcnt(0)
    v_add_f32 v28, v96, v97
    v_add_f32 v29, v112, v113
    v_add_f32 v28, v28, v98
    v_add_f32 v29, v29, v114
    v_add_f32 v28, v28, v99
    v_add_f32 v29, v29, v115
    v_add_f32 v28, v28, v100
    v_add_f32 v29, v29, v116
    v_add_f32 v28, v28, v101
    v_add_f32 v29, v29, v117
    v_add_f32 v28, v28, v102
    v_add_f32 v29, v29, v118
    v_add_f32 v28, v28, v103
    v_add_f32 v29, v29, v119
    v_add_f32 v28, v28, v104
    v_add_f32 v29, v29, v120
    v_add_f32 v28, v28, v105
    v_add_f32 v29, v29, v121
    v_add_f32 v28, v28, v106
    v_add_f32 v29, v29, v122
    v_add_f32 v28, v28, v107
    v_add_f32 v29, v29, v123
    v_add_f32 v28, v28, v108
    v_add_f32 v29, v29, v124
    v_add_f32 v28, v28, v109
    v_add_f32 v29, v29, v125
    v_add_f32 v28, v28, v110
    v_add_f32 v29, v29, v126
    v_add_f32 v28, v28, v111
    v_add_f32 v29, v29, v127
    v_cvt_pk_bf16_f32 v28, v28, v28
    v_lshlrev_b32 v28, 16, v28
    v_cvt_pk_bf16_f32 v29, v29, v29
    v_lshlrev_b32 v29, 16, v29
    v_mul_f32 v30, v28, v28
    v_mul_f32 v30, v30, v28
    s_mov_b32 s40, 0x3d372713
    v_fma_f32 v30, v30, s40, v28
    v_mul_f32 v30, 0x3f4c422a, v30
    v_mul_f32 v30, 0xc038aa3b, v30
    v_exp_f32 v30, v30
    s_nop 0
    v_add_f32 v30, 1.0, v30
    v_rcp_f32 v32, v30
    s_nop 0
    v_mul_f32 v31, v28, v32
    v_fma_f32 v33, -v31, v30, v28
    v_fma_f32 v31, v33, v32, v31
    v_cvt_pk_bf16_f32 v31, v31, v31
    v_lshlrev_b32 v31, 16, v31
    v_mul_f32 v31, v31, v29
    v_cvt_pk_bf16_f32 v31, v31, 0
    v_lshlrev_b32 v26, 2, v0
    s_lshl_b32 s39, s36, 6
    s_add_u32 s39, s39, 0x51000
    v_add_u32 v26, s39, v26
    buffer_store_dword v31, v26, s[20:23], 0 offen
L_ffn1_restore:
    s_nop 4
    s_or_b64 exec, exec, s[42:43]
L_ffn1_end:
    s_nop 4
    s_endpgm
.globl ffn2_kernel
.p2align 8
.type ffn2_kernel,@function
ffn2_kernel:
    s_cmp_ge_u32 s2, 64
    s_cbranch_scc1 L_ffn2_end
    s_load_dwordx2 s[24:25], s[0:1], 64
    s_load_dwordx2 s[26:27], s[0:1], 72
    s_load_dwordx2 s[32:33], s[0:1], 88
    v_and_b32 v1, 63, v0
    s_and_b32 s37, s2, 7
    s_lshl_b32 s37, s37, 3
    s_lshr_b32 s38, s2, 3
    s_add_u32 s36, s37, s38
    v_lshlrev_b32 v2, 10, v0
    s_lshl_b32 s39, s36, 4
    v_add_u32 v2, s39, v2
    v_lshlrev_b32 v3, 2, v0
    s_waitcnt lgkmcnt(0)
    s_mov_b32 s4, s24
    s_mov_b32 s5, s25
    s_mov_b32 s6, 0x1c0000
    s_mov_b32 s7, 0x00020000
    s_mov_b32 s8, s26
    s_mov_b32 s9, s27
    s_mov_b32 s10, 0x400
    s_mov_b32 s11, 0x00020000
    s_mov_b32 s20, s32
    s_mov_b32 s21, s33
    s_mov_b32 s22, 0x60000
    s_mov_b32 s23, 0x00020000
    s_mov_b32 s40, 0x0
    buffer_load_dwordx4 v[64:67], v2, s[4:7], s40 offen
    s_mov_b32 s40, 0x40000
    buffer_load_dwordx4 v[68:71], v2, s[4:7], s40 offen
    s_mov_b32 s40, 0x80000
    buffer_load_dwordx4 v[72:75], v2, s[4:7], s40 offen
    s_mov_b32 s40, 0xc0000
    buffer_load_dwordx4 v[76:79], v2, s[4:7], s40 offen
    s_mov_b32 s40, 0x100000
    buffer_load_dwordx4 v[80:83], v2, s[4:7], s40 offen
    s_mov_b32 s40, 0x140000
    buffer_load_dwordx4 v[84:87], v2, s[4:7], s40 offen
    s_mov_b32 s40, 0x180000
    buffer_load_dwordx4 v[88:91], v2, s[4:7], s40 offen
    s_mov_b32 s40, 0x51000
    buffer_load_dword v8, v3, s[20:23], s40 offen
    s_mov_b32 s40, 0x51400
    buffer_load_dword v9, v3, s[20:23], s40 offen
    s_mov_b32 s40, 0x51800
    buffer_load_dword v10, v3, s[20:23], s40 offen
    s_mov_b32 s40, 0x51c00
    buffer_load_dword v11, v3, s[20:23], s40 offen
    s_mov_b32 s40, 0x52000
    buffer_load_dword v12, v3, s[20:23], s40 offen
    s_mov_b32 s40, 0x52400
    buffer_load_dword v13, v3, s[20:23], s40 offen
    s_mov_b32 s40, 0x52800
    buffer_load_dword v14, v3, s[20:23], s40 offen
    v_and_b32 v4, 7, v0
    v_lshlrev_b32 v4, 2, v4
    s_lshl_b32 s39, s36, 5
    s_add_u32 s39, s39, 0x50000
    v_add_u32 v4, s39, v4
    buffer_load_dword v15, v4, s[20:23], 0 offen
    s_waitcnt vmcnt(0)
    v_lshlrev_b32 v16, 16, v8
    v_dot2_f32_bf16 v32, v8, v64, 0
    v_dot2_f32_bf16 v33, v16, v64, 0
    v_dot2_f32_bf16 v34, v8, v65, 0
    v_dot2_f32_bf16 v35, v16, v65, 0
    v_dot2_f32_bf16 v36, v8, v66, 0
    v_dot2_f32_bf16 v37, v16, v66, 0
    v_dot2_f32_bf16 v38, v8, v67, 0
    v_dot2_f32_bf16 v39, v16, v67, 0
    v_lshlrev_b32 v16, 16, v9
    v_dot2c_f32_bf16 v32, v9, v68
    v_dot2c_f32_bf16 v33, v16, v68
    v_dot2c_f32_bf16 v34, v9, v69
    v_dot2c_f32_bf16 v35, v16, v69
    v_dot2c_f32_bf16 v36, v9, v70
    v_dot2c_f32_bf16 v37, v16, v70
    v_dot2c_f32_bf16 v38, v9, v71
    v_dot2c_f32_bf16 v39, v16, v71
    v_lshlrev_b32 v16, 16, v10
    v_dot2c_f32_bf16 v32, v10, v72
    v_dot2c_f32_bf16 v33, v16, v72
    v_dot2c_f32_bf16 v34, v10, v73
    v_dot2c_f32_bf16 v35, v16, v73
    v_dot2c_f32_bf16 v36, v10, v74
    v_dot2c_f32_bf16 v37, v16, v74
    v_dot2c_f32_bf16 v38, v10, v75
    v_dot2c_f32_bf16 v39, v16, v75
    v_lshlrev_b32 v16, 16, v11
    v_dot2c_f32_bf16 v32, v11, v76
    v_dot2c_f32_bf16 v33, v16, v76
    v_dot2c_f32_bf16 v34, v11, v77
    v_dot2c_f32_bf16 v35, v16, v77
    v_dot2c_f32_bf16 v36, v11, v78
    v_dot2c_f32_bf16 v37, v16, v78
    v_dot2c_f32_bf16 v38, v11, v79
    v_dot2c_f32_bf16 v39, v16, v79
    v_lshlrev_b32 v16, 16, v12
    v_dot2c_f32_bf16 v32, v12, v80
    v_dot2c_f32_bf16 v33, v16, v80
    v_dot2c_f32_bf16 v34, v12, v81
    v_dot2c_f32_bf16 v35, v16, v81
    v_dot2c_f32_bf16 v36, v12, v82
    v_dot2c_f32_bf16 v37, v16, v82
    v_dot2c_f32_bf16 v38, v12, v83
    v_dot2c_f32_bf16 v39, v16, v83
    v_lshlrev_b32 v16, 16, v13
    v_dot2c_f32_bf16 v32, v13, v84
    v_dot2c_f32_bf16 v33, v16, v84
    v_dot2c_f32_bf16 v34, v13, v85
    v_dot2c_f32_bf16 v35, v16, v85
    v_dot2c_f32_bf16 v36, v13, v86
    v_dot2c_f32_bf16 v37, v16, v86
    v_dot2c_f32_bf16 v38, v13, v87
    v_dot2c_f32_bf16 v39, v16, v87
    v_lshlrev_b32 v16, 16, v14
    v_dot2c_f32_bf16 v32, v14, v88
    v_dot2c_f32_bf16 v33, v16, v88
    v_dot2c_f32_bf16 v34, v14, v89
    v_dot2c_f32_bf16 v35, v16, v89
    v_dot2c_f32_bf16 v36, v14, v90
    v_dot2c_f32_bf16 v37, v16, v90
    v_dot2c_f32_bf16 v38, v14, v91
    v_dot2c_f32_bf16 v39, v16, v91
    v_add_f32_dpp v32, v32, v32 row_ror:1 row_mask:0xf bank_mask:0xf
    v_add_f32_dpp v33, v33, v33 row_ror:1 row_mask:0xf bank_mask:0xf
    v_add_f32_dpp v34, v34, v34 row_ror:1 row_mask:0xf bank_mask:0xf
    v_add_f32_dpp v35, v35, v35 row_ror:1 row_mask:0xf bank_mask:0xf
    v_add_f32_dpp v36, v36, v36 row_ror:1 row_mask:0xf bank_mask:0xf
    v_add_f32_dpp v37, v37, v37 row_ror:1 row_mask:0xf bank_mask:0xf
    v_add_f32_dpp v38, v38, v38 row_ror:1 row_mask:0xf bank_mask:0xf
    v_add_f32_dpp v39, v39, v39 row_ror:1 row_mask:0xf bank_mask:0xf
    v_add_f32_dpp v32, v32, v32 row_ror:2 row_mask:0xf bank_mask:0xf
    v_add_f32_dpp v33, v33, v33 row_ror:2 row_mask:0xf bank_mask:0xf
    v_add_f32_dpp v34, v34, v34 row_ror:2 row_mask:0xf bank_mask:0xf
    v_add_f32_dpp v35, v35, v35 row_ror:2 row_mask:0xf bank_mask:0xf
    v_add_f32_dpp v36, v36, v36 row_ror:2 row_mask:0xf bank_mask:0xf
    v_add_f32_dpp v37, v37, v37 row_ror:2 row_mask:0xf bank_mask:0xf
    v_add_f32_dpp v38, v38, v38 row_ror:2 row_mask:0xf bank_mask:0xf
    v_add_f32_dpp v39, v39, v39 row_ror:2 row_mask:0xf bank_mask:0xf
    v_add_f32_dpp v32, v32, v32 row_ror:4 row_mask:0xf bank_mask:0xf
    v_add_f32_dpp v33, v33, v33 row_ror:4 row_mask:0xf bank_mask:0xf
    v_add_f32_dpp v34, v34, v34 row_ror:4 row_mask:0xf bank_mask:0xf
    v_add_f32_dpp v35, v35, v35 row_ror:4 row_mask:0xf bank_mask:0xf
    v_add_f32_dpp v36, v36, v36 row_ror:4 row_mask:0xf bank_mask:0xf
    v_add_f32_dpp v37, v37, v37 row_ror:4 row_mask:0xf bank_mask:0xf
    v_add_f32_dpp v38, v38, v38 row_ror:4 row_mask:0xf bank_mask:0xf
    v_add_f32_dpp v39, v39, v39 row_ror:4 row_mask:0xf bank_mask:0xf
    v_add_f32_dpp v32, v32, v32 row_ror:8 row_mask:0xf bank_mask:0xf
    v_add_f32_dpp v33, v33, v33 row_ror:8 row_mask:0xf bank_mask:0xf
    v_add_f32_dpp v34, v34, v34 row_ror:8 row_mask:0xf bank_mask:0xf
    v_add_f32_dpp v35, v35, v35 row_ror:8 row_mask:0xf bank_mask:0xf
    v_add_f32_dpp v36, v36, v36 row_ror:8 row_mask:0xf bank_mask:0xf
    v_add_f32_dpp v37, v37, v37 row_ror:8 row_mask:0xf bank_mask:0xf
    v_add_f32_dpp v38, v38, v38 row_ror:8 row_mask:0xf bank_mask:0xf
    v_add_f32_dpp v39, v39, v39 row_ror:8 row_mask:0xf bank_mask:0xf
    v_lshrrev_b32 v26, 4, v0
    v_lshlrev_b32 v26, 5, v26
    ds_write_b128 v26, v[32:35] offset:0
    ds_write_b128 v26, v[36:39] offset:16
    s_waitcnt lgkmcnt(0)
    s_barrier
    v_cmp_gt_u32 vcc, 8, v0
    s_nop 0
    s_and_saveexec_b64 s[42:43], vcc
    s_cbranch_execz L_ffn2_restore
    v_lshlrev_b32 v26, 2, v0
    ds_read_b32 v40, v26 offset:0
    ds_read_b32 v41, v26 offset:32
    ds_read_b32 v42, v26 offset:64
    ds_read_b32 v43, v26 offset:96
    ds_read_b32 v44, v26 offset:128
    ds_read_b32 v45, v26 offset:160
    ds_read_b32 v46, v26 offset:192
    ds_read_b32 v47, v26 offset:224
    ds_read_b32 v48, v26 offset:256
    ds_read_b32 v49, v26 offset:288
    ds_read_b32 v50, v26 offset:320
    ds_read_b32 v51, v26 offset:352
    ds_read_b32 v52, v26 offset:384
    ds_read_b32 v53, v26 offset:416
    ds_read_b32 v54, v26 offset:448
    ds_read_b32 v55, v26 offset:480
    s_waitcnt lgkmcnt(0)
    v_add_f32 v27, v40, v41
    v_add_f32 v27, v27, v42
    v_add_f32 v27, v27, v43
    v_add_f32 v27, v27, v44
    v_add_f32 v27, v27, v45
    v_add_f32 v27, v27, v46
    v_add_f32 v27, v27, v47
    v_add_f32 v27, v27, v48
    v_add_f32 v27, v27, v49
    v_add_f32 v27, v27, v50
    v_add_f32 v27, v27, v51
    v_add_f32 v27, v27, v52
    v_add_f32 v27, v27, v53
    v_add_f32 v27, v27, v54
    v_add_f32 v27, v27, v55
    v_cvt_pk_bf16_f32 v27, v27, v27
    v_lshlrev_b32 v27, 16, v27
    v_add_f32 v27, v15, v27
    v_cvt_pk_bf16_f32 v27, v27, 0
    v_lshlrev_b32 v28, 1, v0
    s_lshl_b32 s39, s36, 4
    v_add_u32 v28, s39, v28
    buffer_store_short v27, v28, s[8:11], 0 offen
L_ffn2_restore:
    s_nop 4
    s_or_b64 exec, exec, s[42:43]
L_ffn2_end:
    s_nop 4
    s_endpgm
.section .rodata,"a"
.p2align 6
.amdhsa_kernel attn_kernel
  .amdhsa_next_free_vgpr 256
  .amdhsa_next_free_sgpr 96
  .amdhsa_accum_offset 256
  .amdhsa_group_segment_fixed_size 0
  .amdhsa_kernarg_size 96
  .amdhsa_user_sgpr_count 2
  .amdhsa_user_sgpr_kernarg_segment_ptr 1
  .amdhsa_system_sgpr_workgroup_id_x 1
.end_amdhsa_kernel
.p2align 6
.amdhsa_kernel wo_kernel
  .amdhsa_next_free_vgpr 80
  .amdhsa_next_free_sgpr 96
  .amdhsa_accum_offset 80
  .amdhsa_group_segment_fixed_size 0
  .amdhsa_kernarg_size 96
  .amdhsa_user_sgpr_count 2
  .amdhsa_user_sgpr_kernarg_segment_ptr 1
  .amdhsa_system_sgpr_workgroup_id_x 1
.end_amdhsa_kernel
.p2align 6
.amdhsa_kernel ffn1_kernel
  .amdhsa_next_free_vgpr 160
  .amdhsa_next_free_sgpr 96
  .amdhsa_accum_offset 160
  .amdhsa_group_segment_fixed_size 0
  .amdhsa_kernarg_size 96
  .amdhsa_user_sgpr_count 2
  .amdhsa_user_sgpr_kernarg_segment_ptr 1
  .amdhsa_system_sgpr_workgroup_id_x 1
.end_amdhsa_kernel
.p2align 6
.amdhsa_kernel ffn2_kernel
  .amdhsa_next_free_vgpr 96
  .amdhsa_next_free_sgpr 96
  .amdhsa_accum_offset 96
  .amdhsa_group_segment_fixed_size 0
  .amdhsa_kernarg_size 96
  .amdhsa_user_sgpr_count 2
  .amdhsa_user_sgpr_kernarg_segment_ptr 1
  .amdhsa_system_sgpr_workgroup_id_x 1
.end_amdhsa_kernel
```
